```python
import torch

def _softmax(x, axis=-1):
    return torch.softmax(x, dim=axis)
def _gelu(x):
    return torch.nn.functional.gelu(x, approximate="tanh")
def _silu(x):
    return torch.nn.functional.silu(x)
def _sigmoid(x):
    return torch.sigmoid(x)
def _layernorm(x, axis=-1, eps=1e-5):
    m = x.mean(dim=axis, keepdim=True)
    v = x.var(dim=axis, keepdim=True, unbiased=False)
    return (x - m) / torch.sqrt(v + eps)
def _scatter_add(tgt, idx, src, axis=0):
    return tgt.clone().index_add_(axis, idx, src)
def _segment_sum(src, seg, n):
    out = torch.zeros((n,) + src.shape[1:], dtype=src.dtype)
    return out.index_add_(0, seg, src)
def _pad(x, pw):
    flat = tuple(v for pair in reversed(pw) for v in pair)
    return torch.nn.functional.pad(x, flat)

kernel_name = 'parallel_sum__mha_block__moe_arch_mod__prompt'

def setup_inputs():

    _w = (lambda a: (lambda t: t.to(torch.bfloat16) if t.is_floating_point() else t)(torch.as_tensor(a)))
    def _A_setup():
        B, S, D, H = 1, 2048, 1024, 32
        return {
            "x": _w((lambda *s: torch.randn(*s, dtype=torch.bfloat16) * 0.05)(B, S, D)),
            "wqkv": _w((lambda *s: torch.randn(*s, dtype=torch.bfloat16) * 0.05)(D, 3 * D)),
            "wo": _w((lambda *s: torch.randn(*s, dtype=torch.bfloat16) * 0.05)(D, D)),
        }
    _A_in = _A_setup()

    def _B_setup():
        B, S, D, F, C = 1, 2048, 1024, 3584, 1
        return {
            "x": _w((lambda *s: torch.randn(*s, dtype=torch.bfloat16) * 0.05)(B, S, D)),
            "w_r": _w((lambda *s: torch.randn(*s, dtype=torch.bfloat16) * 0.05)(D)),
            "w_gate": _w((lambda *s: torch.randn(*s, dtype=torch.bfloat16) * 0.05)(D, F)),
            "w_up": _w((lambda *s: torch.randn(*s, dtype=torch.bfloat16) * 0.05)(D, F)),
            "w_down": _w((lambda *s: torch.randn(*s, dtype=torch.bfloat16) * 0.05)(F, D)),
        }
    _B_in = _B_setup()

    return {
        "A_x": _A_in["x"],
        "A_wqkv": _A_in["wqkv"],
        "A_wo": _A_in["wo"],
        "B_x": _B_in["x"],
        "B_w_r": _B_in["w_r"],
        "B_w_gate": _B_in["w_gate"],
        "B_w_up": _B_in["w_up"],
        "B_w_down": _B_in["w_down"],
    }

def reference(A_x, A_wqkv, A_wo, B_x, B_w_r, B_w_gate, B_w_up, B_w_down):
    def _A_ref(x, wqkv, wo):
        B, S, D = x.shape
        H = 32
        Dh = D // H
        qkv = (lambda x, *d: x.permute(*d))((x @ wqkv).reshape(B, S, 3, H, Dh), 2, 0, 3, 1, 4)
        q, k, v = qkv[0], qkv[1], qkv[2]
        scores = torch.einsum("bhqd,bhkd->bhqk", q, k) * (Dh ** -0.5)
        p = _softmax(scores, axis=-1)
        o = torch.einsum("bhqk,bhkd->bhqd", p, v)
        return (lambda x, *d: x.permute(*d))(o, 0, 2, 1, 3).reshape(B, S, D) @ wo

    def _B_ref(x, w_r, w_gate, w_up, w_down):
        B, S, D = x.shape
        C = 1
        r = x @ w_r
        idx = torch.argsort(-r, axis=-1)[:, :C]
        idx_e = (lambda x, n, axis: torch.repeat_interleave(x, n, dim=axis))(idx.reshape(B, C, 1), D, axis=2)
        x_sel = (lambda x, i, axis: torch.take_along_dim(x, i, dim=axis))(x, idx_e, axis=1)
        g = _silu(x_sel @ w_gate)
        u = x_sel @ w_up
        y = (g * u) @ w_down
        r_sel = _sigmoid((lambda x, i, axis: torch.take_along_dim(x, i, dim=axis))(r, idx, axis=1))
        y = y * r_sel.reshape(B, C, 1)
        b_off = (torch.arange(B) * S).reshape(B, 1)
        flat_idx = (idx + b_off).reshape(B * C)
        zero = (x * 0.0).reshape(B * S, D)
        upd = _scatter_add(zero, flat_idx, y.reshape(B * C, D), axis=0)
        return x + upd.reshape(B, S, D)

    x = A_x
    xn = _layernorm(x, axis=-1)
    return x + _A_ref(xn, A_wqkv, A_wo) + _B_ref(xn, B_w_r, B_w_gate, B_w_up, B_w_down)
```

```asm
; @launch grid=(256,1,1) block=(512,1,1) lds=163840
.amdgcn_target "amdgcn-amd-amdhsa--gfx950"
.text
.globl parallel_sum__mha_block__moe_arch_mod__prompt_kernel
.p2align 8
.type parallel_sum__mha_block__moe_arch_mod__prompt_kernel,@function
parallel_sum__mha_block__moe_arch_mod__prompt_kernel:
L_code0:
    s_load_dwordx16 s[64:79], s[0:1], 0
    s_load_dwordx4 s[80:83], s[0:1], 64
    s_load_dwordx2 s[84:85], s[0:1], 80
    s_cmp_ge_u32 s2, 256
    s_cbranch_scc1 L_exit_f
    v_lshrrev_b32 v1, 6, v0
    v_and_b32 v0, 63, v0
    v_readfirstlane_b32 s20, v1
    s_getpc_b64 s[40:41]
L_pc:
    s_sub_u32 s40, s40, L_pc-L_code0
    s_subb_u32 s41, s41, 0
    s_lshr_b32 s42, s2, 3
    s_lshl_b32 s42, s42, 3
    s_add_u32 s42, s42, s20
    s_mul_i32 s42, s42, 2
    v_add_u32 v29, s42, v0
    v_lshlrev_b32 v29, 7, v29
    v_min_u32 v29, L_code1-L_code0-4, v29
    s_mov_b64 exec, 3
    global_load_dword v30, v29, s[40:41]
    s_mov_b64 exec, -1
    s_and_b32 s21, s2, 7
    s_lshl_b32 s21, s21, 1
    s_bfe_u32 s23, s2, 0x10003
    s_add_u32 s21, s21, s23
    s_lshr_b32 s22, s2, 4
    s_cmp_lt_u32 s20, 4
    s_cbranch_scc0 L_prod
    s_waitcnt lgkmcnt(0)
    s_mov_b32 s4, s64
    s_mov_b32 s5, s65
    s_mov_b32 s6, 0x400000
    s_mov_b32 s7, 0x20000
    s_mov_b32 s8, s66
    s_mov_b32 s9, s67
    s_mov_b32 s10, 0x600000
    s_mov_b32 s11, 0x20000
    s_mov_b32 s12, s84
    s_mov_b32 s13, s85
    s_mov_b32 s14, 0x1300000
    s_mov_b32 s15, 0x20000
    s_mov_b32 s16, s72
    s_mov_b32 s17, s73
    s_mov_b32 s18, 0x800
    s_mov_b32 s19, 0x20000
    v_lshlrev_b32 v31, 4, v0
    s_lshl_b32 s43, s2, 3
    s_lshl_b32 s30, s20, 1
    s_add_u32 s43, s43, s30
    s_lshl_b32 s30, s43, 11
    buffer_load_dwordx4 v[96:99], v31, s[4:7], s30 offen offset:0
    buffer_load_dwordx4 v[100:103], v31, s[4:7], s30 offen offset:1024
    buffer_load_dwordx4 v[104:107], v31, s[4:7], s30 offen offset:2048
    buffer_load_dwordx4 v[108:111], v31, s[4:7], s30 offen offset:3072
    buffer_load_dwordx4 v[112:115], v31, s[16:19], 0 offen offset:0
    buffer_load_dwordx4 v[116:119], v31, s[16:19], 0 offen offset:1024
    s_branch L_cons
L_prod:
    s_sub_u32 s24, s20, 4
    v_lshrrev_b32 v5, 3, v0
    v_lshrrev_b32 v6, 4, v0
    v_and_b32 v7, 7, v0
    v_xor_b32 v6, v6, v7
    v_lshlrev_b32 v6, 4, v6
    v_lshl_add_u32 v2, v5, 11, v6
    v_xor_b32 v3, 64, v2
    v_bfe_u32 v6, v0, 4, 1
    v_lshlrev_b32 v6, 2, v6
    v_xor_b32 v6, v6, v7
    v_lshlrev_b32 v6, 4, v6
    v_mul_u32_u24 v4, 6144, v5
    v_add_u32 v4, v4, v6
    s_lshl_b32 s30, s22, 7
    s_lshl_b32 s25, s24, 5
    s_add_u32 s30, s30, s25
    s_lshl_b32 s30, s30, 11
    s_mul_i32 s31, s24, 98304
    s_lshl_b32 s25, s21, 7
    s_add_u32 s31, s31, s25
    s_lshl_b32 s36, s24, 12
    s_lshl_b32 s37, s24, 11
    s_add_u32 s37, s37, 16384
    s_mov_b32 s32, 0
    s_mov_b32 s33, s36
    s_mov_b32 s34, s37
    v_xor_b32 v111, 32, v4
    s_mov_b32 s38, s30
    s_mov_b32 s39, s31
    s_and_b32 s45, s22, 15
    s_lshl_b32 s30, s45, 7
    s_add_u32 s30, s30, s38
    s_mul_i32 s31, s45, 393216
    s_add_u32 s31, s31, s39
    s_waitcnt lgkmcnt(0)
    s_mov_b32 s4, s64
    s_mov_b32 s5, s65
    s_mov_b32 s6, 0x400000
    s_mov_b32 s7, 0x20000
    s_mov_b32 s8, s66
    s_mov_b32 s9, s67
    s_mov_b32 s10, 0x600000
    s_mov_b32 s11, 0x20000
    s_mov_b32 s12, s84
    s_mov_b32 s13, s85
    s_mov_b32 s14, 0x1300000
    s_mov_b32 s15, 0x20000
    s_lshl_b32 s44, s2, 3
    s_add_u32 s44, s44, s20
    v_mov_b32 v8, 262144
    s_cmp_eq_u32 s44, 7
    s_cbranch_scc0 L_1
    buffer_load_dword v9, v8, s[12:15], 0 offen sc1
L_1:
    s_add_u32 m0, s36, 0
    s_add_u32 s35, s30, 0
    buffer_load_dwordx4 v2, s[4:7], s35 offen  lds
    s_add_u32 m0, s36, 1024
    s_add_u32 s35, s30, 16384
    buffer_load_dwordx4 v3, s[4:7], s35 offen  lds
    s_add_u32 m0, s36, 2048
    s_add_u32 s35, s30, 32768
    buffer_load_dwordx4 v2, s[4:7], s35 offen  lds
    s_add_u32 m0, s36, 3072
    s_add_u32 s35, s30, 49152
    buffer_load_dwordx4 v3, s[4:7], s35 offen  lds
    s_add_u32 m0, s37, 0
    s_add_u32 s35, s31, 0
    buffer_load_dwordx4 v4, s[8:11], s35 offen  lds
    s_add_u32 m0, s37, 1024
    s_add_u32 s35, s31, 49152
    buffer_load_dwordx4 v111, s[8:11], s35 offen  lds
    s_add_u32 m0, s37, 8192
    s_add_u32 s35, s31, 2048
    buffer_load_dwordx4 v4, s[8:11], s35 offen  lds
    s_add_u32 m0, s37, 9216
    s_add_u32 s35, s31, 51200
    buffer_load_dwordx4 v111, s[8:11], s35 offen  lds
    s_add_u32 m0, s37, 16384
    s_add_u32 s35, s31, 4096
    buffer_load_dwordx4 v4, s[8:11], s35 offen  lds
    s_add_u32 m0, s37, 17408
    s_add_u32 s35, s31, 53248
    buffer_load_dwordx4 v111, s[8:11], s35 offen  lds
    s_add_u32 s45, s45, 1
    s_and_b32 s45, s45, 15
    s_lshl_b32 s30, s45, 7
    s_add_u32 s30, s30, s38
    s_mul_i32 s31, s45, 393216
    s_add_u32 s31, s31, s39
    s_add_u32 m0, s36, 40960
    s_add_u32 s35, s30, 0
    buffer_load_dwordx4 v2, s[4:7], s35 offen  lds
    s_add_u32 m0, s36, 41984
    s_add_u32 s35, s30, 16384
    buffer_load_dwordx4 v3, s[4:7], s35 offen  lds
    s_add_u32 m0, s36, 43008
    s_add_u32 s35, s30, 32768
    buffer_load_dwordx4 v2, s[4:7], s35 offen  lds
    s_add_u32 m0, s36, 44032
    s_add_u32 s35, s30, 49152
    buffer_load_dwordx4 v3, s[4:7], s35 offen  lds
    s_add_u32 m0, s37, 40960
    s_add_u32 s35, s31, 0
    buffer_load_dwordx4 v4, s[8:11], s35 offen  lds
    s_add_u32 m0, s37, 41984
    s_add_u32 s35, s31, 49152
    buffer_load_dwordx4 v111, s[8:11], s35 offen  lds
    s_add_u32 m0, s37, 49152
    s_add_u32 s35, s31, 2048
    buffer_load_dwordx4 v4, s[8:11], s35 offen  lds
    s_add_u32 m0, s37, 50176
    s_add_u32 s35, s31, 51200
    buffer_load_dwordx4 v111, s[8:11], s35 offen  lds
    s_cmp_eq_u32 s44, 7
    s_cbranch_scc0 L_2
    s_waitcnt vmcnt(18)
    v_add_u32 v9, 2, v9
    v_or_b32 v9, 1, v9
    v_mov_b32 v10, 0
    s_mov_b64 exec, 1
    global_store_dword v10, v9, s[82:83] sc1
    buffer_store_dword v9, v8, s[12:15], 0 offen sc1
    s_mov_b64 exec, -1
    s_nop 1
L_2:
    v_lshrrev_b32 v96, 4, v0
    v_lshlrev_b32 v97, 2, v96
    v_and_b32 v98, 15, v0
    v_xor_b32 v97, v97, v98
    v_lshlrev_b32 v97, 4, v97
    v_lshl_add_u32 v96, v96, 11, v97
    s_mov_b32 s56, s68
    s_mov_b32 s57, s69
    s_mov_b32 s58, 0x200000
    s_mov_b32 s59, 0x20000
    s_lshr_b32 s40, s2, 3
    s_lshl_b32 s40, s40, 2
    s_add_u32 s40, s40, s24
    s_lshl_b32 s40, s40, 14
    s_and_b32 s41, s2, 7
    s_lshl_b32 s41, s41, 8
    s_add_u32 s40, s40, s41
    s_lshl_b32 s42, s24, 11
    s_add_u32 m0, s42, 135168
    s_add_u32 s41, s40, 0
    buffer_load_dwordx4 v96, s[56:59], s41 offen lds
    s_add_u32 m0, s42, 136192
    s_add_u32 s41, s40, 8192
    buffer_load_dwordx4 v96, s[56:59], s41 offen lds
    v_bfe_u32 v96, v0, 2, 2
    v_lshrrev_b32 v97, 5, v0
    v_lshl_add_u32 v97, v97, 2, v96
    v_lshlrev_b32 v97, 8, v97
    v_xor_b32 v96, s24, v96
    v_lshl_add_u32 v97, v96, 6, v97
    v_and_b32 v96, 1, v0
    v_lshl_add_u32 v97, v96, 5, v97
    v_bfe_u32 v96, v0, 4, 1
    v_lshl_add_u32 v97, v96, 4, v97
    v_bfe_u32 v96, v0, 1, 1
    v_lshl_add_u32 v97, v96, 3, v97
    v_add_u32 v97, 135168, v97
    s_and_b32 s40, s2, 7
    s_lshl_b32 s40, s40, 18
    s_lshr_b32 s41, s2, 7
    s_lshl_b32 s41, s41, 2
    s_add_u32 s41, s41, s24
    s_lshl_b32 s41, s41, 15
    s_add_u32 s40, s40, s41
    s_bfe_u32 s41, s2, 0x40003
    s_lshl_b32 s41, s41, 11
    s_add_u32 s40, s40, s41
    s_add_u32 s40, s40, 17825792
    v_lshlrev_b32 v96, 4, v0
    s_cmp_ge_u32 s2, 8
    s_cbranch_scc1 L_3
    s_lshl_b32 s25, s2, 12
    s_lshl_b32 s26, s24, 10
    s_add_u32 s25, s25, s26
    s_add_u32 s25, s25, 229376
    v_mov_b32 v120, 0
    v_mov_b32 v121, 0
    v_mov_b32 v122, 0
    v_mov_b32 v123, 0
    v_lshlrev_b32 v13, 4, v0
    buffer_store_dwordx4 v[120:123], v13, s[12:15], s25 offen sc1
L_3:
    v_mov_b32 v6, 0
    v_lshlrev_b32 v7, 4, v0
    s_getreg_b32 s46, hwreg(HW_REG_XCC_ID)
    s_lshl_b32 s46, s46, 28
    s_lshl_b32 s25, s2, 2
    s_add_u32 s25, s25, 491520
    s_cmp_eq_u32 s24, 3
    s_mov_b32 s27, 491520
    s_cselect_b32 s27, s27, 0x7ffffff0
    v_lshlrev_b32 v9, 2, v0
    s_lshl_b32 s26, s24, 8
    s_add_u32 s26, s26, 122880
    v_add_u32 v10, s26, v9
    v_lshlrev_b32 v11, 3, v0
    v_add_u32 v11, 122880, v11
    v_mov_b32 v12, 124672
    s_waitcnt vmcnt(10)
    s_barrier
    s_add_u32 m0, s37, 57344
    s_add_u32 s35, s31, 4096
    buffer_load_dwordx4 v4, s[8:11], s35 offen  lds
    s_add_u32 m0, s37, 58368
    s_add_u32 s35, s31, 53248
    buffer_load_dwordx4 v111, s[8:11], s35 offen  lds
    s_add_u32 s45, s45, 1
    s_and_b32 s45, s45, 15
    s_lshl_b32 s30, s45, 7
    s_add_u32 s30, s30, s38
    s_mul_i32 s31, s45, 393216
    s_add_u32 s31, s31, s39
    s_add_u32 m0, s36, 81920
    s_add_u32 s35, s30, 0
    buffer_load_dwordx4 v2, s[4:7], s35 offen  lds
    s_add_u32 m0, s36, 82944
    s_add_u32 s35, s30, 16384
    buffer_load_dwordx4 v3, s[4:7], s35 offen  lds
    s_add_u32 m0, s36, 83968
    s_add_u32 s35, s30, 32768
    buffer_load_dwordx4 v2, s[4:7], s35 offen  lds
    s_add_u32 m0, s36, 84992
    s_add_u32 s35, s30, 49152
    buffer_load_dwordx4 v3, s[4:7], s35 offen  lds
    s_add_u32 m0, s37, 81920
    s_add_u32 s35, s31, 0
    buffer_load_dwordx4 v4, s[8:11], s35 offen  lds
    s_add_u32 m0, s37, 82944
    s_add_u32 s35, s31, 49152
    buffer_load_dwordx4 v111, s[8:11], s35 offen  lds
    s_add_u32 m0, s37, 90112
    s_add_u32 s35, s31, 2048
    buffer_load_dwordx4 v4, s[8:11], s35 offen  lds
    s_add_u32 m0, s37, 91136
    s_add_u32 s35, s31, 51200
    buffer_load_dwordx4 v111, s[8:11], s35 offen  lds
    s_add_u32 m0, s37, 98304
    s_add_u32 s35, s31, 4096
    buffer_load_dwordx4 v4, s[8:11], s35 offen  lds
    s_add_u32 m0, s37, 99328
    s_add_u32 s35, s31, 53248
    buffer_load_dwordx4 v111, s[8:11], s35 offen  lds
    s_add_u32 s45, s45, 1
    s_and_b32 s45, s45, 15
    s_lshl_b32 s30, s45, 7
    s_add_u32 s30, s30, s38
    s_mul_i32 s31, s45, 393216
    s_add_u32 s31, s31, s39
    s_waitcnt vmcnt(10)
    s_barrier
    ds_read_b64_tr_b16 v[88:89], v97 offset:0
    ds_read_b64_tr_b16 v[90:91], v97 offset:2048
    ds_read_b64_tr_b16 v[92:93], v97 offset:4096
    ds_read_b64_tr_b16 v[94:95], v97 offset:6144
    s_add_u32 m0, s36, 0
    s_add_u32 s35, s30, 0
    buffer_load_dwordx4 v2, s[4:7], s35 offen  lds
    s_add_u32 m0, s36, 1024
    s_add_u32 s35, s30, 16384
    buffer_load_dwordx4 v3, s[4:7], s35 offen  lds
    s_add_u32 m0, s36, 2048
    s_add_u32 s35, s30, 32768
    buffer_load_dwordx4 v2, s[4:7], s35 offen  lds
    s_add_u32 m0, s36, 3072
    s_add_u32 s35, s30, 49152
    buffer_load_dwordx4 v3, s[4:7], s35 offen  lds
    s_add_u32 m0, s37, 0
    s_add_u32 s35, s31, 0
    buffer_load_dwordx4 v4, s[8:11], s35 offen  lds
    s_add_u32 m0, s37, 1024
    s_add_u32 s35, s31, 49152
    buffer_load_dwordx4 v111, s[8:11], s35 offen  lds
    s_add_u32 m0, s37, 8192
    s_add_u32 s35, s31, 2048
    buffer_load_dwordx4 v4, s[8:11], s35 offen  lds
    s_add_u32 m0, s37, 9216
    s_add_u32 s35, s31, 51200
    buffer_load_dwordx4 v111, s[8:11], s35 offen  lds
    s_add_u32 m0, s37, 16384
    s_add_u32 s35, s31, 4096
    buffer_load_dwordx4 v4, s[8:11], s35 offen  lds
    s_add_u32 m0, s37, 17408
    s_add_u32 s35, s31, 53248
    buffer_load_dwordx4 v111, s[8:11], s35 offen  lds
    s_add_u32 s45, s45, 1
    s_and_b32 s45, s45, 15
    s_lshl_b32 s30, s45, 7
    s_add_u32 s30, s30, s38
    s_mul_i32 s31, s45, 393216
    s_add_u32 s31, s31, s39
    s_waitcnt lgkmcnt(0)
    buffer_store_dwordx4 v[88:91], v96, s[12:15], s40 offen offset:0 sc1
    buffer_store_dwordx4 v[92:95], v96, s[12:15], s40 offen offset:1024 sc1
    s_waitcnt vmcnt(12)
    s_barrier
    s_add_u32 m0, s36, 40960
    s_add_u32 s35, s30, 0
    buffer_load_dwordx4 v2, s[4:7], s35 offen  lds
    s_add_u32 m0, s36, 41984
    s_add_u32 s35, s30, 16384
    buffer_load_dwordx4 v3, s[4:7], s35 offen  lds
    s_add_u32 m0, s36, 43008
    s_add_u32 s35, s30, 32768
    buffer_load_dwordx4 v2, s[4:7], s35 offen  lds
    s_add_u32 m0, s36, 44032
    s_add_u32 s35, s30, 49152
    buffer_load_dwordx4 v3, s[4:7], s35 offen  lds
    s_add_u32 m0, s37, 40960
    s_add_u32 s35, s31, 0
    buffer_load_dwordx4 v4, s[8:11], s35 offen  lds
    s_add_u32 m0, s37, 41984
    s_add_u32 s35, s31, 49152
    buffer_load_dwordx4 v111, s[8:11], s35 offen  lds
    s_add_u32 m0, s37, 49152
    s_add_u32 s35, s31, 2048
    buffer_load_dwordx4 v4, s[8:11], s35 offen  lds
    s_add_u32 m0, s37, 50176
    s_add_u32 s35, s31, 51200
    buffer_load_dwordx4 v111, s[8:11], s35 offen  lds
    s_add_u32 m0, s37, 57344
    s_add_u32 s35, s31, 4096
    buffer_load_dwordx4 v4, s[8:11], s35 offen  lds
    s_add_u32 m0, s37, 58368
    s_add_u32 s35, s31, 53248
    buffer_load_dwordx4 v111, s[8:11], s35 offen  lds
    s_add_u32 s45, s45, 1
    s_and_b32 s45, s45, 15
    s_lshl_b32 s30, s45, 7
    s_add_u32 s30, s30, s38
    s_mul_i32 s31, s45, 393216
    s_add_u32 s31, s31, s39
    global_load_dword v5, v6, s[82:83] sc1
    s_waitcnt vmcnt(13)
    s_barrier
    s_add_u32 m0, s36, 81920
    s_add_u32 s35, s30, 0
    buffer_load_dwordx4 v2, s[4:7], s35 offen  lds
    s_add_u32 m0, s36, 82944
    s_add_u32 s35, s30, 16384
    buffer_load_dwordx4 v3, s[4:7], s35 offen  lds
    s_add_u32 m0, s36, 83968
    s_add_u32 s35, s30, 32768
    buffer_load_dwordx4 v2, s[4:7], s35 offen  lds
    s_add_u32 m0, s36, 84992
    s_add_u32 s35, s30, 49152
    buffer_load_dwordx4 v3, s[4:7], s35 offen  lds
    s_add_u32 m0, s37, 81920
    s_add_u32 s35, s31, 0
    buffer_load_dwordx4 v4, s[8:11], s35 offen  lds
    s_add_u32 m0, s37, 82944
    s_add_u32 s35, s31, 49152
    buffer_load_dwordx4 v111, s[8:11], s35 offen  lds
    s_add_u32 m0, s37, 90112
    s_add_u32 s35, s31, 2048
    buffer_load_dwordx4 v4, s[8:11], s35 offen  lds
    s_add_u32 m0, s37, 91136
    s_add_u32 s35, s31, 51200
    buffer_load_dwordx4 v111, s[8:11], s35 offen  lds
    s_add_u32 m0, s37, 98304
    s_add_u32 s35, s31, 4096
    buffer_load_dwordx4 v4, s[8:11], s35 offen  lds
    s_add_u32 m0, s37, 99328
    s_add_u32 s35, s31, 53248
    buffer_load_dwordx4 v111, s[8:11], s35 offen  lds
    s_add_u32 s45, s45, 1
    s_and_b32 s45, s45, 15
    s_lshl_b32 s30, s45, 7
    s_add_u32 s30, s30, s38
    s_mul_i32 s31, s45, 393216
    s_add_u32 s31, s31, s39
    s_waitcnt vmcnt(11)
    s_waitcnt vmcnt(10)
    s_barrier
    s_add_u32 m0, s36, 0
    s_add_u32 s35, s30, 0
    buffer_load_dwordx4 v2, s[4:7], s35 offen  lds
    s_add_u32 m0, s36, 1024
    s_add_u32 s35, s30, 16384
    buffer_load_dwordx4 v3, s[4:7], s35 offen  lds
    s_add_u32 m0, s36, 2048
    s_add_u32 s35, s30, 32768
    buffer_load_dwordx4 v2, s[4:7], s35 offen  lds
    s_add_u32 m0, s36, 3072
    s_add_u32 s35, s30, 49152
    buffer_load_dwordx4 v3, s[4:7], s35 offen  lds
    s_add_u32 m0, s37, 0
    s_add_u32 s35, s31, 0
    buffer_load_dwordx4 v4, s[8:11], s35 offen  lds
    s_add_u32 m0, s37, 1024
    s_add_u32 s35, s31, 49152
    buffer_load_dwordx4 v111, s[8:11], s35 offen  lds
    s_add_u32 m0, s37, 8192
    s_add_u32 s35, s31, 2048
    buffer_load_dwordx4 v4, s[8:11], s35 offen  lds
    s_add_u32 m0, s37, 9216
    s_add_u32 s35, s31, 51200
    buffer_load_dwordx4 v111, s[8:11], s35 offen  lds
    s_add_u32 m0, s37, 16384
    s_add_u32 s35, s31, 4096
    buffer_load_dwordx4 v4, s[8:11], s35 offen  lds
    s_add_u32 m0, s37, 17408
    s_add_u32 s35, s31, 53248
    buffer_load_dwordx4 v111, s[8:11], s35 offen  lds
    s_add_u32 s45, s45, 1
    s_and_b32 s45, s45, 15
    s_lshl_b32 s30, s45, 7
    s_add_u32 s30, s30, s38
    s_mul_i32 s31, s45, 393216
    s_add_u32 s31, s31, s39
    s_cmp_eq_u32 s24, 3
    s_cbranch_scc0 L_4
    s_mov_b32 s3, 300000
L_spin_5:
    v_readfirstlane_b32 s23, v5
    s_nop 1
    s_cmp_lg_u32 s23, 0
    s_cbranch_scc1 L_ok_6
    global_load_dword v5, v6, s[82:83] sc1
    s_waitcnt vmcnt(0)
    s_sub_u32 s3, s3, 1
    s_cmp_lg_u32 s3, 0
    s_cbranch_scc1 L_spin_5
    s_endpgm
L_ok_6:
    s_xor_b32 s26, s46, s23
    v_mov_b32 v5, s26
    s_mov_b64 exec, 1
    buffer_store_dword v5, v6, s[12:15], s25 offen sc1
    s_mov_b64 exec, -1
L_4:
    s_waitcnt vmcnt(10)
    s_barrier
    s_add_u32 m0, s36, 40960
    s_add_u32 s35, s30, 0
    buffer_load_dwordx4 v2, s[4:7], s35 offen  lds
    s_add_u32 m0, s36, 41984
    s_add_u32 s35, s30, 16384
    buffer_load_dwordx4 v3, s[4:7], s35 offen  lds
    s_add_u32 m0, s36, 43008
    s_add_u32 s35, s30, 32768
    buffer_load_dwordx4 v2, s[4:7], s35 offen  lds
    s_add_u32 m0, s36, 44032
    s_add_u32 s35, s30, 49152
    buffer_load_dwordx4 v3, s[4:7], s35 offen  lds
    s_add_u32 m0, s37, 40960
    s_add_u32 s35, s31, 0
    buffer_load_dwordx4 v4, s[8:11], s35 offen  lds
    s_add_u32 m0, s37, 41984
    s_add_u32 s35, s31, 49152
    buffer_load_dwordx4 v111, s[8:11], s35 offen  lds
    s_add_u32 m0, s37, 49152
    s_add_u32 s35, s31, 2048
    buffer_load_dwordx4 v4, s[8:11], s35 offen  lds
    s_add_u32 m0, s37, 50176
    s_add_u32 s35, s31, 51200
    buffer_load_dwordx4 v111, s[8:11], s35 offen  lds
    s_add_u32 m0, s37, 57344
    s_add_u32 s35, s31, 4096
    buffer_load_dwordx4 v4, s[8:11], s35 offen  lds
    s_add_u32 m0, s37, 58368
    s_add_u32 s35, s31, 53248
    buffer_load_dwordx4 v111, s[8:11], s35 offen  lds
    s_add_u32 s45, s45, 1
    s_and_b32 s45, s45, 15
    s_lshl_b32 s30, s45, 7
    s_add_u32 s30, s30, s38
    s_mul_i32 s31, s45, 393216
    s_add_u32 s31, s31, s39
    s_waitcnt vmcnt(10)
    s_barrier
    s_add_u32 m0, s36, 81920
    s_add_u32 s35, s30, 0
    buffer_load_dwordx4 v2, s[4:7], s35 offen  lds
    s_add_u32 m0, s36, 82944
    s_add_u32 s35, s30, 16384
    buffer_load_dwordx4 v3, s[4:7], s35 offen  lds
    s_add_u32 m0, s36, 83968
    s_add_u32 s35, s30, 32768
    buffer_load_dwordx4 v2, s[4:7], s35 offen  lds
    s_add_u32 m0, s36, 84992
    s_add_u32 s35, s30, 49152
    buffer_load_dwordx4 v3, s[4:7], s35 offen  lds
    s_add_u32 m0, s37, 81920
    s_add_u32 s35, s31, 0
    buffer_load_dwordx4 v4, s[8:11], s35 offen  lds
    s_add_u32 m0, s37, 82944
    s_add_u32 s35, s31, 49152
    buffer_load_dwordx4 v111, s[8:11], s35 offen  lds
    s_add_u32 m0, s37, 90112
    s_add_u32 s35, s31, 2048
    buffer_load_dwordx4 v4, s[8:11], s35 offen  lds
    s_add_u32 m0, s37, 91136
    s_add_u32 s35, s31, 51200
    buffer_load_dwordx4 v111, s[8:11], s35 offen  lds
    s_add_u32 m0, s37, 98304
    s_add_u32 s35, s31, 4096
    buffer_load_dwordx4 v4, s[8:11], s35 offen  lds
    s_add_u32 m0, s37, 99328
    s_add_u32 s35, s31, 53248
    buffer_load_dwordx4 v111, s[8:11], s35 offen  lds
    s_add_u32 s45, s45, 1
    s_and_b32 s45, s45, 15
    s_lshl_b32 s30, s45, 7
    s_add_u32 s30, s30, s38
    s_mul_i32 s31, s45, 393216
    s_add_u32 s31, s31, s39
    s_waitcnt vmcnt(10)
    s_barrier
    s_add_u32 m0, s36, 0
    s_add_u32 s35, s30, 0
    buffer_load_dwordx4 v2, s[4:7], s35 offen  lds
    s_add_u32 m0, s36, 1024
    s_add_u32 s35, s30, 16384
    buffer_load_dwordx4 v3, s[4:7], s35 offen  lds
    s_add_u32 m0, s36, 2048
    s_add_u32 s35, s30, 32768
    buffer_load_dwordx4 v2, s[4:7], s35 offen  lds
    s_add_u32 m0, s36, 3072
    s_add_u32 s35, s30, 49152
    buffer_load_dwordx4 v3, s[4:7], s35 offen  lds
    s_add_u32 m0, s37, 0
    s_add_u32 s35, s31, 0
    buffer_load_dwordx4 v4, s[8:11], s35 offen  lds
    s_add_u32 m0, s37, 1024
    s_add_u32 s35, s31, 49152
    buffer_load_dwordx4 v111, s[8:11], s35 offen  lds
    s_add_u32 m0, s37, 8192
    s_add_u32 s35, s31, 2048
    buffer_load_dwordx4 v4, s[8:11], s35 offen  lds
    s_add_u32 m0, s37, 9216
    s_add_u32 s35, s31, 51200
    buffer_load_dwordx4 v111, s[8:11], s35 offen  lds
    s_add_u32 m0, s37, 16384
    s_add_u32 s35, s31, 4096
    buffer_load_dwordx4 v4, s[8:11], s35 offen  lds
    s_add_u32 m0, s37, 17408
    s_add_u32 s35, s31, 53248
    buffer_load_dwordx4 v111, s[8:11], s35 offen  lds
    s_add_u32 s45, s45, 1
    s_and_b32 s45, s45, 15
    s_lshl_b32 s30, s45, 7
    s_add_u32 s30, s30, s38
    s_mul_i32 s31, s45, 393216
    s_add_u32 s31, s31, s39
    s_waitcnt vmcnt(10)
    s_barrier
    s_add_u32 m0, s36, 40960
    s_add_u32 s35, s30, 0
    buffer_load_dwordx4 v2, s[4:7], s35 offen  lds
    s_add_u32 m0, s36, 41984
    s_add_u32 s35, s30, 16384
    buffer_load_dwordx4 v3, s[4:7], s35 offen  lds
    s_add_u32 m0, s36, 43008
    s_add_u32 s35, s30, 32768
    buffer_load_dwordx4 v2, s[4:7], s35 offen  lds
    s_add_u32 m0, s36, 44032
    s_add_u32 s35, s30, 49152
    buffer_load_dwordx4 v3, s[4:7], s35 offen  lds
    s_add_u32 m0, s37, 40960
    s_add_u32 s35, s31, 0
    buffer_load_dwordx4 v4, s[8:11], s35 offen  lds
    s_add_u32 m0, s37, 41984
    s_add_u32 s35, s31, 49152
    buffer_load_dwordx4 v111, s[8:11], s35 offen  lds
    s_add_u32 m0, s37, 49152
    s_add_u32 s35, s31, 2048
    buffer_load_dwordx4 v4, s[8:11], s35 offen  lds
    s_add_u32 m0, s37, 50176
    s_add_u32 s35, s31, 51200
    buffer_load_dwordx4 v111, s[8:11], s35 offen  lds
    s_add_u32 m0, s37, 57344
    s_add_u32 s35, s31, 4096
    buffer_load_dwordx4 v4, s[8:11], s35 offen  lds
    s_add_u32 m0, s37, 58368
    s_add_u32 s35, s31, 53248
    buffer_load_dwordx4 v111, s[8:11], s35 offen  lds
    s_add_u32 s45, s45, 1
    s_and_b32 s45, s45, 15
    s_lshl_b32 s30, s45, 7
    s_add_u32 s30, s30, s38
    s_mul_i32 s31, s45, 393216
    s_add_u32 s31, s31, s39
    s_waitcnt vmcnt(10)
    s_barrier
    s_add_u32 m0, s36, 81920
    s_add_u32 s35, s30, 0
    buffer_load_dwordx4 v2, s[4:7], s35 offen  lds
    s_add_u32 m0, s36, 82944
    s_add_u32 s35, s30, 16384
    buffer_load_dwordx4 v3, s[4:7], s35 offen  lds
    s_add_u32 m0, s36, 83968
    s_add_u32 s35, s30, 32768
    buffer_load_dwordx4 v2, s[4:7], s35 offen  lds
    s_add_u32 m0, s36, 84992
    s_add_u32 s35, s30, 49152
    buffer_load_dwordx4 v3, s[4:7], s35 offen  lds
    s_add_u32 m0, s37, 81920
    s_add_u32 s35, s31, 0
    buffer_load_dwordx4 v4, s[8:11], s35 offen  lds
    s_add_u32 m0, s37, 82944
    s_add_u32 s35, s31, 49152
    buffer_load_dwordx4 v111, s[8:11], s35 offen  lds
    s_add_u32 m0, s37, 90112
    s_add_u32 s35, s31, 2048
    buffer_load_dwordx4 v4, s[8:11], s35 offen  lds
    s_add_u32 m0, s37, 91136
    s_add_u32 s35, s31, 51200
    buffer_load_dwordx4 v111, s[8:11], s35 offen  lds
    s_add_u32 m0, s37, 98304
    s_add_u32 s35, s31, 4096
    buffer_load_dwordx4 v4, s[8:11], s35 offen  lds
    s_add_u32 m0, s37, 99328
    s_add_u32 s35, s31, 53248
    buffer_load_dwordx4 v111, s[8:11], s35 offen  lds
    s_add_u32 s45, s45, 1
    s_and_b32 s45, s45, 15
    s_lshl_b32 s30, s45, 7
    s_add_u32 s30, s30, s38
    s_mul_i32 s31, s45, 393216
    s_add_u32 s31, s31, s39
    s_waitcnt vmcnt(10)
    s_barrier
    s_add_u32 m0, s36, 0
    s_add_u32 s35, s30, 0
    buffer_load_dwordx4 v2, s[4:7], s35 offen  lds
    s_add_u32 m0, s36, 1024
    s_add_u32 s35, s30, 16384
    buffer_load_dwordx4 v3, s[4:7], s35 offen  lds
    s_add_u32 m0, s36, 2048
    s_add_u32 s35, s30, 32768
    buffer_load_dwordx4 v2, s[4:7], s35 offen  lds
    s_add_u32 m0, s36, 3072
    s_add_u32 s35, s30, 49152
    buffer_load_dwordx4 v3, s[4:7], s35 offen  lds
    s_add_u32 m0, s37, 0
    s_add_u32 s35, s31, 0
    buffer_load_dwordx4 v4, s[8:11], s35 offen  lds
    s_add_u32 m0, s37, 1024
    s_add_u32 s35, s31, 49152
    buffer_load_dwordx4 v111, s[8:11], s35 offen  lds
    s_add_u32 m0, s37, 8192
    s_add_u32 s35, s31, 2048
    buffer_load_dwordx4 v4, s[8:11], s35 offen  lds
    s_add_u32 m0, s37, 9216
    s_add_u32 s35, s31, 51200
    buffer_load_dwordx4 v111, s[8:11], s35 offen  lds
    s_add_u32 m0, s37, 16384
    s_add_u32 s35, s31, 4096
    buffer_load_dwordx4 v4, s[8:11], s35 offen  lds
    s_add_u32 m0, s37, 17408
    s_add_u32 s35, s31, 53248
    buffer_load_dwordx4 v111, s[8:11], s35 offen  lds
    s_add_u32 s45, s45, 1
    s_and_b32 s45, s45, 15
    s_lshl_b32 s30, s45, 7
    s_add_u32 s30, s30, s38
    s_mul_i32 s31, s45, 393216
    s_add_u32 s31, s31, s39
    s_waitcnt vmcnt(10)
    s_barrier
    s_add_u32 m0, s36, 40960
    s_add_u32 s35, s30, 0
    buffer_load_dwordx4 v2, s[4:7], s35 offen  lds
    s_add_u32 m0, s36, 41984
    s_add_u32 s35, s30, 16384
    buffer_load_dwordx4 v3, s[4:7], s35 offen  lds
    s_add_u32 m0, s36, 43008
    s_add_u32 s35, s30, 32768
    buffer_load_dwordx4 v2, s[4:7], s35 offen  lds
    s_add_u32 m0, s36, 44032
    s_add_u32 s35, s30, 49152
    buffer_load_dwordx4 v3, s[4:7], s35 offen  lds
    s_add_u32 m0, s37, 40960
    s_add_u32 s35, s31, 0
    buffer_load_dwordx4 v4, s[8:11], s35 offen  lds
    s_add_u32 m0, s37, 41984
    s_add_u32 s35, s31, 49152
    buffer_load_dwordx4 v111, s[8:11], s35 offen  lds
    s_add_u32 m0, s37, 49152
    s_add_u32 s35, s31, 2048
    buffer_load_dwordx4 v4, s[8:11], s35 offen  lds
    s_add_u32 m0, s37, 50176
    s_add_u32 s35, s31, 51200
    buffer_load_dwordx4 v111, s[8:11], s35 offen  lds
    s_add_u32 m0, s37, 57344
    s_add_u32 s35, s31, 4096
    buffer_load_dwordx4 v4, s[8:11], s35 offen  lds
    s_add_u32 m0, s37, 58368
    s_add_u32 s35, s31, 53248
    buffer_load_dwordx4 v111, s[8:11], s35 offen  lds
    s_add_u32 s45, s45, 1
    s_and_b32 s45, s45, 15
    s_lshl_b32 s30, s45, 7
    s_add_u32 s30, s30, s38
    s_mul_i32 s31, s45, 393216
    s_add_u32 s31, s31, s39
    s_waitcnt vmcnt(10)
    s_barrier
    buffer_load_dwordx4 v[112:115], v7, s[12:15], s27 offen sc1
    s_add_u32 m0, s36, 81920
    s_add_u32 s35, s30, 0
    buffer_load_dwordx4 v2, s[4:7], s35 offen  lds
    s_add_u32 m0, s36, 82944
    s_add_u32 s35, s30, 16384
    buffer_load_dwordx4 v3, s[4:7], s35 offen  lds
    s_add_u32 m0, s36, 83968
    s_add_u32 s35, s30, 32768
    buffer_load_dwordx4 v2, s[4:7], s35 offen  lds
    s_add_u32 m0, s36, 84992
    s_add_u32 s35, s30, 49152
    buffer_load_dwordx4 v3, s[4:7], s35 offen  lds
    s_add_u32 m0, s37, 81920
    s_add_u32 s35, s31, 0
    buffer_load_dwordx4 v4, s[8:11], s35 offen  lds
    s_add_u32 m0, s37, 82944
    s_add_u32 s35, s31, 49152
    buffer_load_dwordx4 v111, s[8:11], s35 offen  lds
    s_add_u32 m0, s37, 90112
    s_add_u32 s35, s31, 2048
    buffer_load_dwordx4 v4, s[8:11], s35 offen  lds
    s_add_u32 m0, s37, 91136
    s_add_u32 s35, s31, 51200
    buffer_load_dwordx4 v111, s[8:11], s35 offen  lds
    s_add_u32 m0, s37, 98304
    s_add_u32 s35, s31, 4096
    buffer_load_dwordx4 v4, s[8:11], s35 offen  lds
    s_add_u32 m0, s37, 99328
    s_add_u32 s35, s31, 53248
    buffer_load_dwordx4 v111, s[8:11], s35 offen  lds
    s_add_u32 s45, s45, 1
    s_and_b32 s45, s45, 15
    s_lshl_b32 s30, s45, 7
    s_add_u32 s30, s30, s38
    s_mul_i32 s31, s45, 393216
    s_add_u32 s31, s31, s39
    s_waitcnt vmcnt(11)
    s_barrier
    s_add_u32 m0, s36, 0
    s_add_u32 s35, s30, 0
    buffer_load_dwordx4 v2, s[4:7], s35 offen  lds
    s_add_u32 m0, s36, 1024
    s_add_u32 s35, s30, 16384
    buffer_load_dwordx4 v3, s[4:7], s35 offen  lds
    s_add_u32 m0, s36, 2048
    s_add_u32 s35, s30, 32768
    buffer_load_dwordx4 v2, s[4:7], s35 offen  lds
    s_add_u32 m0, s36, 3072
    s_add_u32 s35, s30, 49152
    buffer_load_dwordx4 v3, s[4:7], s35 offen  lds
    s_add_u32 m0, s37, 0
    s_add_u32 s35, s31, 0
    buffer_load_dwordx4 v4, s[8:11], s35 offen  lds
    s_add_u32 m0, s37, 1024
    s_add_u32 s35, s31, 49152
    buffer_load_dwordx4 v111, s[8:11], s35 offen  lds
    s_add_u32 m0, s37, 8192
    s_add_u32 s35, s31, 2048
    buffer_load_dwordx4 v4, s[8:11], s35 offen  lds
    s_add_u32 m0, s37, 9216
    s_add_u32 s35, s31, 51200
    buffer_load_dwordx4 v111, s[8:11], s35 offen  lds
    s_add_u32 m0, s37, 16384
    s_add_u32 s35, s31, 4096
    buffer_load_dwordx4 v4, s[8:11], s35 offen  lds
    s_add_u32 m0, s37, 17408
    s_add_u32 s35, s31, 53248
    buffer_load_dwordx4 v111, s[8:11], s35 offen  lds
    s_add_u32 s45, s45, 1
    s_and_b32 s45, s45, 15
    s_lshl_b32 s30, s45, 7
    s_add_u32 s30, s30, s38
    s_mul_i32 s31, s45, 393216
    s_add_u32 s31, s31, s39
    s_cmp_eq_u32 s24, 3
    s_cbranch_scc0 L_7
    s_waitcnt vmcnt(20)
    s_mov_b32 s3, 300000
L_spin_8:
    v_xor_b32 v112, s23, v112
    v_xor_b32 v113, s23, v113
    v_xor_b32 v114, s23, v114
    v_xor_b32 v115, s23, v115
    v_or_b32 v8, v112, v113
    v_or3_b32 v8, v8, v114, v115
    v_lshlrev_b32 v8, 4, v8
    v_cmp_ne_u32 vcc, 0, v8
    s_nop 1
    s_cmp_eq_u64 vcc, 0
    s_cbranch_scc1 L_ok_9
    buffer_load_dwordx4 v[112:115], v7, s[12:15], s27 offen sc1
    s_waitcnt vmcnt(0)
    s_sub_u32 s3, s3, 1
    s_cmp_lg_u32 s3, 0
    s_cbranch_scc1 L_spin_8
    s_endpgm
L_ok_9:
    v_cmp_ne_u32 s[48:49], s46, v112
    v_cmp_ne_u32 s[50:51], s46, v113
    v_cmp_ne_u32 s[52:53], s46, v114
    v_cmp_ne_u32 s[54:55], s46, v115
    s_nop 1
    s_bitcmp1_b32 s2, 0
    s_cselect_b64 s[48:49], s[50:51], s[48:49]
    s_cselect_b64 s[52:53], s[54:55], s[52:53]
    s_bitcmp1_b32 s2, 1
    s_cselect_b64 s[48:49], s[52:53], s[48:49]
    s_bitcmp1_b32 s2, 2
    s_mov_b32 s50, 0x55555555
    s_cselect_b32 s50, 0xaaaaaaaa, s50
    s_or_b32 s48, s48, s49
    s_and_b32 s47, s48, s50
L_7:
    s_waitcnt vmcnt(10)
    s_barrier
    s_cmp_eq_u32 s24, 3
    s_cbranch_scc1 L_10
    s_mul_i32 s25, s21, 12288
    s_lshl_b32 s26, s24, 8
    s_add_u32 s25, s25, s26
    s_add_u32 s25, s25, 32768
    buffer_load_dword v40, v9, s[12:15], s25 offen offset:0 sc1
    buffer_load_dword v41, v9, s[12:15], s25 offen offset:768 sc1
    buffer_load_dword v42, v9, s[12:15], s25 offen offset:1536 sc1
    buffer_load_dword v43, v9, s[12:15], s25 offen offset:2304 sc1
    s_add_u32 s25, s25, 3072
    buffer_load_dword v44, v9, s[12:15], s25 offen offset:0 sc1
    buffer_load_dword v45, v9, s[12:15], s25 offen offset:768 sc1
    buffer_load_dword v46, v9, s[12:15], s25 offen offset:1536 sc1
    buffer_load_dword v47, v9, s[12:15], s25 offen offset:2304 sc1
    s_add_u32 s25, s25, 3072
    buffer_load_dword v48, v9, s[12:15], s25 offen offset:0 sc1
    buffer_load_dword v49, v9, s[12:15], s25 offen offset:768 sc1
    buffer_load_dword v50, v9, s[12:15], s25 offen offset:1536 sc1
    buffer_load_dword v51, v9, s[12:15], s25 offen offset:2304 sc1
    s_add_u32 s25, s25, 3072
    buffer_load_dword v52, v9, s[12:15], s25 offen offset:0 sc1
    buffer_load_dword v53, v9, s[12:15], s25 offen offset:768 sc1
    buffer_load_dword v54, v9, s[12:15], s25 offen offset:1536 sc1
    buffer_load_dword v55, v9, s[12:15], s25 offen offset:2304 sc1
    s_branch L_11
L_10:
    v_lshlrev_b32 v8, 4, v0
    s_lshl_b32 s25, s22, 10
    s_add_u32 s25, s25, 0
    buffer_load_dwordx4 v[40:43], v8, s[12:15], s25 offen sc1
    v_lshlrev_b32 v64, 4, v0
    s_mov_b32 s61, 16384
    buffer_load_dwordx4 v[68:71], v64, s[12:15], s61 offen sc1
    s_mov_b32 s61, 17408
    buffer_load_dwordx4 v[72:75], v64, s[12:15], s61 offen sc1
    s_mov_b32 s61, 18432
    buffer_load_dwordx4 v[76:79], v64, s[12:15], s61 offen sc1
    s_mov_b32 s61, 19456
    buffer_load_dwordx4 v[80:83], v64, s[12:15], s61 offen sc1
    s_mov_b32 s25, 0x7ffffff0
L_11:
    s_cmp_eq_u32 s24, 3
    s_cbranch_scc1 L_12
    s_waitcnt vmcnt(16)
    s_branch L_13
L_12:
    s_waitcnt vmcnt(5)
L_13:
    s_barrier
    s_waitcnt vmcnt(0)
    s_cmp_eq_u32 s24, 3
    s_cbranch_scc1 L_14
    v_add_f32 v40, v40, v48
    v_add_f32 v41, v41, v49
    v_add_f32 v42, v42, v50
    v_add_f32 v43, v43, v51
    v_add_f32 v44, v44, v52
    v_add_f32 v45, v45, v53
    v_add_f32 v46, v46, v54
    v_add_f32 v47, v47, v55
    v_add_f32 v40, v40, v44
    v_add_f32 v41, v41, v45
    v_add_f32 v42, v42, v46
    v_add_f32 v43, v43, v47
    v_add_f32 v40, v40, v42
    v_add_f32 v41, v41, v43
    v_add_f32 v40, v40, v41
    ds_write_b32 v10, v40
    s_branch L_15
L_14:
    v_xor_b32 v44, 0x80000000, v40
    v_xor_b32 v45, 0x80000000, v42
    v_mov_b32 v42, v41
    ds_write_b64 v11, v[44:45] offset:768
    ds_write_b64 v11, v[42:43] offset:1280
    v_mov_b32 v8, s23
    v_mov_b32 v10, s47
    ds_write_b32 v12, v8
    ds_write_b32 v12, v10 offset:8
L_15:
    s_waitcnt lgkmcnt(0)
    s_barrier
    v_mov_b32 v8, 124672
    ds_read_b128 v[8:11], v8
    s_waitcnt lgkmcnt(0)
    v_readfirstlane_b32 s23, v8
    v_readfirstlane_b32 s60, v10
    s_nop 1
    s_cmp_eq_u32 s24, 3
    s_cbranch_scc0 L_16
    v_max3_u32 v68, v68, v69, v70
    v_max3_u32 v68, v68, v71, v72
    v_max3_u32 v68, v68, v73, v74
    v_max3_u32 v68, v68, v75, v76
    v_max3_u32 v68, v68, v77, v78
    v_max3_u32 v68, v68, v79, v80
    v_max3_u32 v68, v68, v81, v82
    v_max_u32 v68, v68, v83
    s_nop 1
    v_max_u32_dpp v68, v68, v68 row_shr:1 bound_ctrl:0
    s_nop 1
    v_max_u32_dpp v68, v68, v68 row_shr:2 bound_ctrl:0
    s_nop 1
    v_max_u32_dpp v68, v68, v68 row_shr:4 bound_ctrl:0
    s_nop 1
    v_max_u32_dpp v68, v68, v68 row_shr:8 bound_ctrl:0
    s_nop 1
    v_max_u32_dpp v68, v68, v68 row_bcast:15 row_mask:0xa
    s_nop 1
    v_max_u32_dpp v68, v68, v68 row_bcast:31 row_mask:0xc
    s_nop 1
    v_readlane_b32 s62, v68, 63
    s_nop 1
    s_and_b32 s63, s62, 0xffff
    s_sub_u32 s63, 2047, s63
    s_lshl_b32 s48, s63, 11
    v_lshlrev_b32 v8, 2, v0
    buffer_load_dword v16, v8, s[4:7], s48 offen offset:0
    buffer_load_dword v17, v8, s[4:7], s48 offen offset:256
    buffer_load_dword v18, v8, s[4:7], s48 offen offset:512
    buffer_load_dword v19, v8, s[4:7], s48 offen offset:768
    buffer_load_dword v20, v8, s[4:7], s48 offen offset:1024
    buffer_load_dword v21, v8, s[4:7], s48 offen offset:1280
    buffer_load_dword v22, v8, s[4:7], s48 offen offset:1536
    buffer_load_dword v23, v8, s[4:7], s48 offen offset:1792
    s_lshl_b32 s48, s63, 3
    s_add_u32 s48, s48, 0
    v_mov_b32 v9, 0
    buffer_load_dwordx2 v[26:27], v9, s[12:15], s48 offen sc1
    v_mov_b32 v10, s62
    ds_write_b32 v12, v10 offset:4
    v_mov_b32 v123, 0
    v_and_b32 v120, 0x31, v0
    v_bfe_u32 v121, v0, 1, 2
    v_lshl_or_b32 v120, v121, 2, v120
    v_bfe_u32 v121, v0, 3, 1
    v_lshl_or_b32 v120, v121, 1, v120
    v_lshlrev_b32 v120, 2, v120
    v_add_u32 v120, 131072, v120
    v_and_b32 v122, 3, v0
    v_lshlrev_b32 v122, 2, v122
    v_add_u32 v122, 133120, v122
    ds_write_b32 v122, v123
    s_waitcnt vmcnt(0)
    v_and_b32 v121, 0xffff0000, v16
    v_lshlrev_b32 v16, 16, v16
    v_sub_f32 v16, v16, v26
    v_sub_f32 v121, v121, v26
    v_cvt_pk_bf16_f32 v16, v16, v121
    v_and_b32 v121, 0xffff0000, v16
    v_lshlrev_b32 v16, 16, v16
    v_mul_f32 v16, v16, v27
    v_mul_f32 v121, v121, v27
    v_cvt_pk_bf16_f32 v16, v16, v121
    ds_write_b32 v120, v16 offset:0
    v_and_b32 v121, 0xffff0000, v17
    v_lshlrev_b32 v17, 16, v17
    v_sub_f32 v17, v17, v26
    v_sub_f32 v121, v121, v26
    v_cvt_pk_bf16_f32 v17, v17, v121
    v_and_b32 v121, 0xffff0000, v17
    v_lshlrev_b32 v17, 16, v17
    v_mul_f32 v17, v17, v27
    v_mul_f32 v121, v121, v27
    v_cvt_pk_bf16_f32 v17, v17, v121
    ds_write_b32 v120, v17 offset:256
    v_and_b32 v121, 0xffff0000, v18
    v_lshlrev_b32 v18, 16, v18
    v_sub_f32 v18, v18, v26
    v_sub_f32 v121, v121, v26
    v_cvt_pk_bf16_f32 v18, v18, v121
    v_and_b32 v121, 0xffff0000, v18
    v_lshlrev_b32 v18, 16, v18
    v_mul_f32 v18, v18, v27
    v_mul_f32 v121, v121, v27
    v_cvt_pk_bf16_f32 v18, v18, v121
    ds_write_b32 v120, v18 offset:512
    v_and_b32 v121, 0xffff0000, v19
    v_lshlrev_b32 v19, 16, v19
    v_sub_f32 v19, v19, v26
    v_sub_f32 v121, v121, v26
    v_cvt_pk_bf16_f32 v19, v19, v121
    v_and_b32 v121, 0xffff0000, v19
    v_lshlrev_b32 v19, 16, v19
    v_mul_f32 v19, v19, v27
    v_mul_f32 v121, v121, v27
    v_cvt_pk_bf16_f32 v19, v19, v121
    ds_write_b32 v120, v19 offset:768
    v_and_b32 v121, 0xffff0000, v20
    v_lshlrev_b32 v20, 16, v20
    v_sub_f32 v20, v20, v26
    v_sub_f32 v121, v121, v26
    v_cvt_pk_bf16_f32 v20, v20, v121
    v_and_b32 v121, 0xffff0000, v20
    v_lshlrev_b32 v20, 16, v20
    v_mul_f32 v20, v20, v27
    v_mul_f32 v121, v121, v27
    v_cvt_pk_bf16_f32 v20, v20, v121
    ds_write_b32 v120, v20 offset:1024
    v_and_b32 v121, 0xffff0000, v21
    v_lshlrev_b32 v21, 16, v21
    v_sub_f32 v21, v21, v26
    v_sub_f32 v121, v121, v26
    v_cvt_pk_bf16_f32 v21, v21, v121
    v_and_b32 v121, 0xffff0000, v21
    v_lshlrev_b32 v21, 16, v21
    v_mul_f32 v21, v21, v27
    v_mul_f32 v121, v121, v27
    v_cvt_pk_bf16_f32 v21, v21, v121
    ds_write_b32 v120, v21 offset:1280
    v_and_b32 v121, 0xffff0000, v22
    v_lshlrev_b32 v22, 16, v22
    v_sub_f32 v22, v22, v26
    v_sub_f32 v121, v121, v26
    v_cvt_pk_bf16_f32 v22, v22, v121
    v_and_b32 v121, 0xffff0000, v22
    v_lshlrev_b32 v22, 16, v22
    v_mul_f32 v22, v22, v27
    v_mul_f32 v121, v121, v27
    v_cvt_pk_bf16_f32 v22, v22, v121
    ds_write_b32 v120, v22 offset:1536
    v_and_b32 v121, 0xffff0000, v23
    v_lshlrev_b32 v23, 16, v23
    v_sub_f32 v23, v23, v26
    v_sub_f32 v121, v121, v26
    v_cvt_pk_bf16_f32 v23, v23, v121
    v_and_b32 v121, 0xffff0000, v23
    v_lshlrev_b32 v23, 16, v23
    v_mul_f32 v23, v23, v27
    v_mul_f32 v121, v121, v27
    v_cvt_pk_bf16_f32 v23, v23, v121
    ds_write_b32 v120, v23 offset:1792
L_16:
    s_branch L_join
L_drain:
    s_waitcnt vmcnt(0)
    s_branch L_drained
L_cons:
    s_and_b32 s25, s20, 1
    s_lshr_b32 s26, s20, 1
    v_and_b32 v1, 15, v0
    v_lshrrev_b32 v2, 4, v0
    v_bfe_u32 v3, v0, 1, 3
    v_xor_b32 v3, v3, v2
    v_lshlrev_b32 v3, 4, v3
    v_lshl_add_u32 v3, v1, 7, v3
    s_lshl_b32 s27, s26, 13
    v_add_u32 v8, s27, v3
    v_xor_b32 v9, 64, v8
    v_bfe_u32 v3, v0, 2, 2
    v_lshl_add_u32 v4, v2, 3, v3
    v_lshlrev_b32 v4, 7, v4
    v_and_b32 v3, 2, v3
    v_and_b32 v5, 1, v2
    v_or_b32 v3, v3, v5
    s_lshl_b32 s27, s25, 1
    v_xor_b32 v3, s27, v3
    v_lshl_add_u32 v4, v3, 5, v4
    v_and_b32 v3, 3, v0
    v_lshl_add_u32 v4, v3, 3, v4
    v_add_u32 v10, 16384, v4
    v_xor_b32 v11, 32, v10
    v_mov_b32 v16, v8
    v_mov_b32 v17, v9
    v_mov_b32 v18, v10
    v_mov_b32 v19, v11
    v_mov_b32 v20, 0x3f803f80
    v_mov_b32 v21, 0x3f803f80
    v_mov_b32 v22, 0x3f803f80
    v_mov_b32 v23, 0x3f803f80
    v_cmp_gt_u32 vcc, 16, v0
    v_lshlrev_b32 v24, 2, v0
    v_mov_b32 v3, 0x7ffffff0
    v_cndmask_b32 v24, v3, v24, vcc
    s_lshl_b32 s35, s21, 4
    s_add_u32 s35, s35, s22
    s_mul_i32 s35, s35, 768
    s_lshl_b32 s27, s25, 7
    s_add_u32 s35, s35, s27
    s_add_u32 s35, s35, 32768
    s_cmp_lg_u32 s26, 0
    s_cselect_b32 s35, 0x7ffffff0, s35
    s_waitcnt vmcnt(0)
    v_lshlrev_b32 v32, 16, v96
    v_and_b32 v33, 0xffff0000, v96
    v_lshlrev_b32 v34, 16, v97
    v_and_b32 v35, 0xffff0000, v97
    v_lshlrev_b32 v36, 16, v98
    v_and_b32 v37, 0xffff0000, v98
    v_lshlrev_b32 v38, 16, v99
    v_and_b32 v39, 0xffff0000, v99
    v_lshlrev_b32 v40, 16, v100
    v_and_b32 v41, 0xffff0000, v100
    v_lshlrev_b32 v42, 16, v101
    v_and_b32 v43, 0xffff0000, v101
    v_lshlrev_b32 v44, 16, v102
    v_and_b32 v45, 0xffff0000, v102
    v_lshlrev_b32 v46, 16, v103
    v_and_b32 v47, 0xffff0000, v103
    v_lshlrev_b32 v48, 16, v104
    v_and_b32 v49, 0xffff0000, v104
    v_lshlrev_b32 v50, 16, v105
    v_and_b32 v51, 0xffff0000, v105
    v_lshlrev_b32 v52, 16, v106
    v_and_b32 v53, 0xffff0000, v106
    v_lshlrev_b32 v54, 16, v107
    v_and_b32 v55, 0xffff0000, v107
    v_lshlrev_b32 v56, 16, v108
    v_and_b32 v57, 0xffff0000, v108
    v_lshlrev_b32 v58, 16, v109
    v_and_b32 v59, 0xffff0000, v109
    v_lshlrev_b32 v60, 16, v110
    v_and_b32 v61, 0xffff0000, v110
    v_lshlrev_b32 v62, 16, v111
    v_and_b32 v63, 0xffff0000, v111
    v_lshlrev_b32 v64, 16, v112
    v_and_b32 v65, 0xffff0000, v112
    v_lshlrev_b32 v66, 16, v113
    v_and_b32 v67, 0xffff0000, v113
    v_lshlrev_b32 v68, 16, v114
    v_and_b32 v69, 0xffff0000, v114
    v_lshlrev_b32 v70, 16, v115
    v_and_b32 v71, 0xffff0000, v115
    v_lshlrev_b32 v72, 16, v116
    v_and_b32 v73, 0xffff0000, v116
    v_lshlrev_b32 v74, 16, v117
    v_and_b32 v75, 0xffff0000, v117
    v_lshlrev_b32 v76, 16, v118
    v_and_b32 v77, 0xffff0000, v118
    v_lshlrev_b32 v78, 16, v119
    v_and_b32 v79, 0xffff0000, v119
    v_pk_mul_f32 v[84:85], v[32:33], v[32:33]
    v_pk_mul_f32 v[88:89], v[32:33], v[64:65]
    v_pk_mul_f32 v[86:87], v[48:49], v[48:49]
    v_pk_mul_f32 v[90:91], v[48:49], v[64:65]
    v_pk_add_f32 v[80:81], v[32:33], v[34:35]
    v_pk_fma_f32 v[84:85], v[34:35], v[34:35], v[84:85]
    v_pk_fma_f32 v[88:89], v[34:35], v[66:67], v[88:89]
    v_pk_add_f32 v[82:83], v[48:49], v[50:51]
    v_pk_fma_f32 v[86:87], v[50:51], v[50:51], v[86:87]
    v_pk_fma_f32 v[90:91], v[50:51], v[66:67], v[90:91]
    v_pk_add_f32 v[92:93], v[64:65], v[66:67]
    v_pk_add_f32 v[80:81], v[80:81], v[36:37]
    v_pk_fma_f32 v[84:85], v[36:37], v[36:37], v[84:85]
    v_pk_fma_f32 v[88:89], v[36:37], v[68:69], v[88:89]
    v_pk_add_f32 v[82:83], v[82:83], v[52:53]
    v_pk_fma_f32 v[86:87], v[52:53], v[52:53], v[86:87]
    v_pk_fma_f32 v[90:91], v[52:53], v[68:69], v[90:91]
    v_pk_add_f32 v[92:93], v[92:93], v[68:69]
    v_pk_add_f32 v[80:81], v[80:81], v[38:39]
    v_pk_fma_f32 v[84:85], v[38:39], v[38:39], v[84:85]
    v_pk_fma_f32 v[88:89], v[38:39], v[70:71], v[88:89]
    v_pk_add_f32 v[82:83], v[82:83], v[54:55]
    v_pk_fma_f32 v[86:87], v[54:55], v[54:55], v[86:87]
    v_pk_fma_f32 v[90:91], v[54:55], v[70:71], v[90:91]
    v_pk_add_f32 v[92:93], v[92:93], v[70:71]
    v_pk_add_f32 v[80:81], v[80:81], v[40:41]
    v_pk_fma_f32 v[84:85], v[40:41], v[40:41], v[84:85]
    v_pk_fma_f32 v[88:89], v[40:41], v[72:73], v[88:89]
    v_pk_add_f32 v[82:83], v[82:83], v[56:57]
    v_pk_fma_f32 v[86:87], v[56:57], v[56:57], v[86:87]
    v_pk_fma_f32 v[90:91], v[56:57], v[72:73], v[90:91]
    v_pk_add_f32 v[92:93], v[92:93], v[72:73]
    v_pk_add_f32 v[80:81], v[80:81], v[42:43]
    v_pk_fma_f32 v[84:85], v[42:43], v[42:43], v[84:85]
    v_pk_fma_f32 v[88:89], v[42:43], v[74:75], v[88:89]
    v_pk_add_f32 v[82:83], v[82:83], v[58:59]
    v_pk_fma_f32 v[86:87], v[58:59], v[58:59], v[86:87]
    v_pk_fma_f32 v[90:91], v[58:59], v[74:75], v[90:91]
    v_pk_add_f32 v[92:93], v[92:93], v[74:75]
    v_pk_add_f32 v[80:81], v[80:81], v[44:45]
    v_pk_fma_f32 v[84:85], v[44:45], v[44:45], v[84:85]
    v_pk_fma_f32 v[88:89], v[44:45], v[76:77], v[88:89]
    v_pk_add_f32 v[82:83], v[82:83], v[60:61]
    v_pk_fma_f32 v[86:87], v[60:61], v[60:61], v[86:87]
    v_pk_fma_f32 v[90:91], v[60:61], v[76:77], v[90:91]
    v_pk_add_f32 v[92:93], v[92:93], v[76:77]
    v_pk_add_f32 v[80:81], v[80:81], v[46:47]
    v_pk_fma_f32 v[84:85], v[46:47], v[46:47], v[84:85]
    v_pk_fma_f32 v[88:89], v[46:47], v[78:79], v[88:89]
    v_pk_add_f32 v[82:83], v[82:83], v[62:63]
    v_pk_fma_f32 v[86:87], v[62:63], v[62:63], v[86:87]
    v_pk_fma_f32 v[90:91], v[62:63], v[78:79], v[90:91]
    v_pk_add_f32 v[92:93], v[92:93], v[78:79]
    v_add_f32 v96, v80, v81
    v_add_f32 v97, v82, v83
    v_add_f32 v98, v84, v85
    v_add_f32 v99, v86, v87
    v_add_f32 v100, v88, v89
    v_add_f32 v101, v90, v91
    v_add_f32 v102, v92, v93
    s_nop 1
    v_add_f32_dpp v96, v96, v96 row_shr:1 bound_ctrl:0
    v_add_f32_dpp v97, v97, v97 row_shr:1 bound_ctrl:0
    v_add_f32_dpp v98, v98, v98 row_shr:1 bound_ctrl:0
    v_add_f32_dpp v99, v99, v99 row_shr:1 bound_ctrl:0
    v_add_f32_dpp v100, v100, v100 row_shr:1 bound_ctrl:0
    v_add_f32_dpp v101, v101, v101 row_shr:1 bound_ctrl:0
    v_add_f32_dpp v102, v102, v102 row_shr:1 bound_ctrl:0
    v_add_f32_dpp v96, v96, v96 row_shr:2 bound_ctrl:0
    v_add_f32_dpp v97, v97, v97 row_shr:2 bound_ctrl:0
    v_add_f32_dpp v98, v98, v98 row_shr:2 bound_ctrl:0
    v_add_f32_dpp v99, v99, v99 row_shr:2 bound_ctrl:0
    v_add_f32_dpp v100, v100, v100 row_shr:2 bound_ctrl:0
    v_add_f32_dpp v101, v101, v101 row_shr:2 bound_ctrl:0
    v_add_f32_dpp v102, v102, v102 row_shr:2 bound_ctrl:0
    v_add_f32_dpp v96, v96, v96 row_shr:4 bound_ctrl:0
    v_add_f32_dpp v97, v97, v97 row_shr:4 bound_ctrl:0
    v_add_f32_dpp v98, v98, v98 row_shr:4 bound_ctrl:0
    v_add_f32_dpp v99, v99, v99 row_shr:4 bound_ctrl:0
    v_add_f32_dpp v100, v100, v100 row_shr:4 bound_ctrl:0
    v_add_f32_dpp v101, v101, v101 row_shr:4 bound_ctrl:0
    v_add_f32_dpp v102, v102, v102 row_shr:4 bound_ctrl:0
    v_add_f32_dpp v96, v96, v96 row_shr:8 bound_ctrl:0
    v_add_f32_dpp v97, v97, v97 row_shr:8 bound_ctrl:0
    v_add_f32_dpp v98, v98, v98 row_shr:8 bound_ctrl:0
    v_add_f32_dpp v99, v99, v99 row_shr:8 bound_ctrl:0
    v_add_f32_dpp v100, v100, v100 row_shr:8 bound_ctrl:0
    v_add_f32_dpp v101, v101, v101 row_shr:8 bound_ctrl:0
    v_add_f32_dpp v102, v102, v102 row_shr:8 bound_ctrl:0
    v_add_f32_dpp v96, v96, v96 row_bcast:15 row_mask:0xa
    v_add_f32_dpp v97, v97, v97 row_bcast:15 row_mask:0xa
    v_add_f32_dpp v98, v98, v98 row_bcast:15 row_mask:0xa
    v_add_f32_dpp v99, v99, v99 row_bcast:15 row_mask:0xa
    v_add_f32_dpp v100, v100, v100 row_bcast:15 row_mask:0xa
    v_add_f32_dpp v101, v101, v101 row_bcast:15 row_mask:0xa
    v_add_f32_dpp v102, v102, v102 row_bcast:15 row_mask:0xa
    v_add_f32_dpp v96, v96, v96 row_bcast:31 row_mask:0xc
    v_add_f32_dpp v97, v97, v97 row_bcast:31 row_mask:0xc
    v_add_f32_dpp v98, v98, v98 row_bcast:31 row_mask:0xc
    v_add_f32_dpp v99, v99, v99 row_bcast:31 row_mask:0xc
    v_add_f32_dpp v100, v100, v100 row_bcast:31 row_mask:0xc
    v_add_f32_dpp v101, v101, v101 row_bcast:31 row_mask:0xc
    v_add_f32_dpp v102, v102, v102 row_bcast:31 row_mask:0xc
    v_mov_b32 v106, 0x3a800000
    v_readlane_b32 s30, v96, 63
    v_readlane_b32 s31, v97, 63
    v_readlane_b32 s32, v98, 63
    v_readlane_b32 s33, v99, 63
    v_mul_f32 v96, s30, v106
    v_mul_f32 v97, s31, v106
    v_readlane_b32 s30, v100, 63
    v_readlane_b32 s31, v101, 63
    v_readlane_b32 s34, v102, 63
    v_mul_f32 v99, s32, v106
    v_mul_f32 v100, s33, v106
    v_mov_b32 v104, s30
    v_mov_b32 v105, s31
    v_mov_b32 v98, s34
    v_fma_f32 v99, -v96, v96, v99
    v_fma_f32 v100, -v97, v97, v100
    v_max_f32 v99, 0, v99
    v_max_f32 v100, 0, v100
    v_cvt_pk_bf16_f32 v96, v96, v97
    v_and_b32 v97, 0xffff0000, v96
    v_lshlrev_b32 v96, 16, v96
    v_cvt_pk_bf16_f32 v99, v99, v100
    v_and_b32 v100, 0xffff0000, v99
    v_lshlrev_b32 v99, 16, v99
    v_add_f32 v99, 0x3727c5ac, v99
    v_add_f32 v100, 0x3727c5ac, v100
    v_cvt_pk_bf16_f32 v99, v99, v100
    v_and_b32 v100, 0xffff0000, v99
    v_lshlrev_b32 v99, 16, v99
    v_sqrt_f32 v99, v99
    v_sqrt_f32 v100, v100
    s_nop 0
    v_cvt_pk_bf16_f32 v99, v99, v100
    v_and_b32 v100, 0xffff0000, v99
    v_lshlrev_b32 v99, 16, v99
    v_rcp_f32 v99, v99
    v_rcp_f32 v100, v100
    v_fma_f32 v104, -v96, v98, v104
    v_fma_f32 v105, -v97, v98, v105
    v_mul_f32 v104, v104, v99
    v_mul_f32 v105, v105, v100
    v_cvt_pk_bf16_f32 v104, v104, v104
    v_and_b32 v104, 0xffff0000, v104
    v_ashrrev_i32 v103, 31, v104
    v_or_b32 v103, 0x80000000, v103
    v_xor_b32 v104, v104, v103
    v_and_b32 v104, 0xffff0000, v104
    s_sub_u32 s33, 2047, s43
    v_or_b32 v104, s33, v104
    v_cvt_pk_bf16_f32 v105, v105, v105
    v_and_b32 v105, 0xffff0000, v105
    v_ashrrev_i32 v103, 31, v105
    v_or_b32 v103, 0x80000000, v103
    v_xor_b32 v105, v105, v103
    v_and_b32 v105, 0xffff0000, v105
    s_sub_u32 s33, 2046, s43
    v_or_b32 v105, s33, v105
    v_max_u32 v101, v104, v105
    v_cmp_eq_u32 vcc, 1, v0
    s_lshl_b32 s33, s43, 3
    s_add_u32 s33, s33, 0
    v_cndmask_b32 v104, v96, v97, vcc
    v_cndmask_b32 v105, v99, v100, vcc
    v_lshlrev_b32 v106, 3, v0
    s_lshl_b32 s34, s43, 1
    s_add_u32 s34, s34, 16384
    v_mov_b32 v107, 0
    s_mov_b64 exec, 3
    buffer_store_dwordx2 v[104:105], v106, s[12:15], s33 offen sc1
    s_mov_b64 exec, 1
    buffer_store_dword v101, v107, s[12:15], s34 offen sc1
    s_mov_b64 exec, -1
    s_barrier
    ds_read_b64_tr_b16 a[16:17], v18 offset:0
    ds_read_b64_tr_b16 a[18:19], v18 offset:512
    ds_read_b128 a[0:3], v16 offset:0
    ds_read_b128 a[4:7], v16 offset:2048
    ds_read_b128 a[8:11], v16 offset:4096
    ds_read_b128 a[12:15], v16 offset:6144
    ds_read_b64_tr_b16 a[20:21], v19 offset:0
    ds_read_b64_tr_b16 a[22:23], v19 offset:512
    ds_read_b64_tr_b16 a[24:25], v18 offset:8192
    ds_read_b64_tr_b16 a[26:27], v18 offset:8704
    ds_read_b64_tr_b16 a[28:29], v19 offset:8192
    ds_read_b64_tr_b16 a[30:31], v19 offset:8704
    ds_read_b64_tr_b16 a[32:33], v18 offset:16384
    ds_read_b64_tr_b16 a[34:35], v18 offset:16896
    ds_read_b64_tr_b16 a[36:37], v19 offset:16384
    ds_read_b64_tr_b16 a[38:39], v19 offset:16896
    s_mov_b32 s28, 0
    s_mov_b32 s29, 15
    s_waitcnt lgkmcnt(0)
    v_mfma_f32_16x16x32_bf16 v[32:35], a[16:19], a[0:3], 0
    ds_read_b64_tr_b16 a[56:57], v18 offset:4096
    v_mfma_f32_16x16x32_bf16 v[36:39], a[16:19], a[4:7], 0
    ds_read_b64_tr_b16 a[58:59], v18 offset:4608
    v_mfma_f32_16x16x32_bf16 v[40:43], a[16:19], a[8:11], 0
    ds_read_b128 a[40:43], v17 offset:0
    v_mfma_f32_16x16x32_bf16 v[44:47], a[16:19], a[12:15], 0
    ds_read_b128 a[44:47], v17 offset:2048
    v_mfma_f32_16x16x32_bf16 a[80:83], v[20:23], a[16:19], 0
    ds_read_b128 a[48:51], v17 offset:4096
    v_mfma_f32_16x16x32_bf16 v[48:51], a[20:23], a[0:3], 0
    ds_read_b128 a[52:55], v17 offset:6144
    v_mfma_f32_16x16x32_bf16 v[52:55], a[20:23], a[4:7], 0
    ds_read_b64_tr_b16 a[60:61], v19 offset:4096
    v_mfma_f32_16x16x32_bf16 v[56:59], a[20:23], a[8:11], 0
    ds_read_b64_tr_b16 a[62:63], v19 offset:4608
    v_mfma_f32_16x16x32_bf16 v[60:63], a[20:23], a[12:15], 0
    ds_read_b64_tr_b16 a[64:65], v18 offset:12288
    v_mfma_f32_16x16x32_bf16 a[84:87], v[20:23], a[20:23], 0
    ds_read_b64_tr_b16 a[66:67], v18 offset:12800
    v_mfma_f32_16x16x32_bf16 v[64:67], a[24:27], a[0:3], 0
    ds_read_b64_tr_b16 a[68:69], v19 offset:12288
    v_mfma_f32_16x16x32_bf16 v[68:71], a[24:27], a[4:7], 0
    ds_read_b64_tr_b16 a[70:71], v19 offset:12800
    v_mfma_f32_16x16x32_bf16 v[72:75], a[24:27], a[8:11], 0
    ds_read_b64_tr_b16 a[72:73], v18 offset:20480
    v_mfma_f32_16x16x32_bf16 v[76:79], a[24:27], a[12:15], 0
    ds_read_b64_tr_b16 a[74:75], v18 offset:20992
    v_mfma_f32_16x16x32_bf16 a[88:91], v[20:23], a[24:27], 0
    ds_read_b64_tr_b16 a[76:77], v19 offset:20480
    v_mfma_f32_16x16x32_bf16 v[80:83], a[28:31], a[0:3], 0
    ds_read_b64_tr_b16 a[78:79], v19 offset:20992
    v_mfma_f32_16x16x32_bf16 v[84:87], a[28:31], a[4:7], 0
    s_add_u32 s28, s28, 40960
    v_mfma_f32_16x16x32_bf16 v[88:91], a[28:31], a[8:11], 0
    s_cmp_eq_u32 s28, 122880
    v_mfma_f32_16x16x32_bf16 v[92:95], a[28:31], a[12:15], 0
    s_cselect_b32 s28, 0, s28
    v_mfma_f32_16x16x32_bf16 a[92:95], v[20:23], a[28:31], 0
    v_mfma_f32_16x16x32_bf16 v[96:99], a[0:3], a[32:35], 0
    v_add_u32 v16, s28, v8
    v_mfma_f32_16x16x32_bf16 v[100:103], a[4:7], a[32:35], 0
    v_mfma_f32_16x16x32_bf16 v[104:107], a[8:11], a[32:35], 0
    v_mfma_f32_16x16x32_bf16 v[108:111], a[12:15], a[32:35], 0
    v_mfma_f32_16x16x32_bf16 a[96:99], v[20:23], a[32:35], 0
    v_mfma_f32_16x16x32_bf16 v[112:115], a[0:3], a[36:39], 0
    v_mfma_f32_16x16x32_bf16 v[116:119], a[4:7], a[36:39], 0
    v_mfma_f32_16x16x32_bf16 v[120:123], a[8:11], a[36:39], 0
    v_mfma_f32_16x16x32_bf16 v[124:127], a[12:15], a[36:39], 0
    v_mfma_f32_16x16x32_bf16 a[100:103], v[20:23], a[36:39], 0
    s_waitcnt lgkmcnt(0)
    v_mfma_f32_16x16x32_bf16 v[32:35], a[56:59], a[40:43], v[32:35]
    v_add_u32 v18, s28, v10
    v_add_u32 v19, s28, v11
    v_mfma_f32_16x16x32_bf16 v[36:39], a[56:59], a[44:47], v[36:39]
    s_barrier
    v_mfma_f32_16x16x32_bf16 v[40:43], a[56:59], a[48:51], v[40:43]
    ds_read_b64_tr_b16 a[16:17], v18 offset:0
    v_mfma_f32_16x16x32_bf16 v[44:47], a[56:59], a[52:55], v[44:47]
    ds_read_b64_tr_b16 a[18:19], v18 offset:512
    v_mfma_f32_16x16x32_bf16 a[80:83], v[20:23], a[56:59], a[80:83]
    ds_read_b128 a[0:3], v16 offset:0
    v_mfma_f32_16x16x32_bf16 v[48:51], a[60:63], a[40:43], v[48:51]
    ds_read_b128 a[4:7], v16 offset:2048
    v_mfma_f32_16x16x32_bf16 v[52:55], a[60:63], a[44:47], v[52:55]
    ds_read_b128 a[8:11], v16 offset:4096
    v_mfma_f32_16x16x32_bf16 v[56:59], a[60:63], a[48:51], v[56:59]
    ds_read_b128 a[12:15], v16 offset:6144
    v_mfma_f32_16x16x32_bf16 v[60:63], a[60:63], a[52:55], v[60:63]
    ds_read_b64_tr_b16 a[20:21], v19 offset:0
    v_mfma_f32_16x16x32_bf16 a[84:87], v[20:23], a[60:63], a[84:87]
    ds_read_b64_tr_b16 a[22:23], v19 offset:512
    v_mfma_f32_16x16x32_bf16 v[64:67], a[64:67], a[40:43], v[64:67]
    ds_read_b64_tr_b16 a[24:25], v18 offset:8192
    v_mfma_f32_16x16x32_bf16 v[68:71], a[64:67], a[44:47], v[68:71]
    ds_read_b64_tr_b16 a[26:27], v18 offset:8704
    v_mfma_f32_16x16x32_bf16 v[72:75], a[64:67], a[48:51], v[72:75]
    ds_read_b64_tr_b16 a[28:29], v19 offset:8192
    v_mfma_f32_16x16x32_bf16 v[76:79], a[64:67], a[52:55], v[76:79]
    ds_read_b64_tr_b16 a[30:31], v19 offset:8704
    v_mfma_f32_16x16x32_bf16 a[88:91], v[20:23], a[64:67], a[88:91]
    ds_read_b64_tr_b16 a[32:33], v18 offset:16384
    v_mfma_f32_16x16x32_bf16 v[80:83], a[68:71], a[40:43], v[80:83]
    ds_read_b64_tr_b16 a[34:35], v18 offset:16896
    v_mfma_f32_16x16x32_bf16 v[84:87], a[68:71], a[44:47], v[84:87]
    ds_read_b64_tr_b16 a[36:37], v19 offset:16384
    v_mfma_f32_16x16x32_bf16 v[88:91], a[68:71], a[48:51], v[88:91]
    ds_read_b64_tr_b16 a[38:39], v19 offset:16896
    v_mfma_f32_16x16x32_bf16 v[92:95], a[68:71], a[52:55], v[92:95]
    v_mfma_f32_16x16x32_bf16 a[92:95], v[20:23], a[68:71], a[92:95]
    v_add_u32 v17, s28, v9
    v_mfma_f32_16x16x32_bf16 v[96:99], a[40:43], a[72:75], v[96:99]
    v_mfma_f32_16x16x32_bf16 v[100:103], a[44:47], a[72:75], v[100:103]
    v_mfma_f32_16x16x32_bf16 v[104:107], a[48:51], a[72:75], v[104:107]
    v_mfma_f32_16x16x32_bf16 v[108:111], a[52:55], a[72:75], v[108:111]
    v_mfma_f32_16x16x32_bf16 a[96:99], v[20:23], a[72:75], a[96:99]
    v_mfma_f32_16x16x32_bf16 v[112:115], a[40:43], a[76:79], v[112:115]
    v_mfma_f32_16x16x32_bf16 v[116:119], a[44:47], a[76:79], v[116:119]
    v_mfma_f32_16x16x32_bf16 v[120:123], a[48:51], a[76:79], v[120:123]
    v_mfma_f32_16x16x32_bf16 v[124:127], a[52:55], a[76:79], v[124:127]
    v_mfma_f32_16x16x32_bf16 a[100:103], v[20:23], a[76:79], a[100:103]
    s_nop 6
    buffer_store_dword a80, v24, s[12:15], s35 offen offset:0 sc1
    buffer_store_dword a84, v24, s[12:15], s35 offen offset:64 sc1
    buffer_store_dword a88, v24, s[12:15], s35 offen offset:256 sc1
    buffer_store_dword a92, v24, s[12:15], s35 offen offset:320 sc1
    buffer_store_dword a96, v24, s[12:15], s35 offen offset:512 sc1
    buffer_store_dword a100, v24, s[12:15], s35 offen offset:576 sc1
.p2align 6
L_gemm_17:
    s_waitcnt lgkmcnt(0)
    v_mfma_f32_16x16x32_bf16 v[32:35], a[16:19], a[0:3], v[32:35]
    ds_read_b64_tr_b16 a[56:57], v18 offset:4096
    v_mfma_f32_16x16x32_bf16 v[36:39], a[16:19], a[4:7], v[36:39]
    ds_read_b64_tr_b16 a[58:59], v18 offset:4608
    v_mfma_f32_16x16x32_bf16 v[40:43], a[16:19], a[8:11], v[40:43]
    ds_read_b128 a[40:43], v17 offset:0
    v_mfma_f32_16x16x32_bf16 v[44:47], a[16:19], a[12:15], v[44:47]
    ds_read_b128 a[44:47], v17 offset:2048
    v_mfma_f32_16x16x32_bf16 v[60:63], a[20:23], a[12:15], v[60:63]
    ds_read_b128 a[48:51], v17 offset:4096
    v_mfma_f32_16x16x32_bf16 v[56:59], a[20:23], a[8:11], v[56:59]
    ds_read_b128 a[52:55], v17 offset:6144
    v_mfma_f32_16x16x32_bf16 v[52:55], a[20:23], a[4:7], v[52:55]
    ds_read_b64_tr_b16 a[60:61], v19 offset:4096
    v_mfma_f32_16x16x32_bf16 v[48:51], a[20:23], a[0:3], v[48:51]
    ds_read_b64_tr_b16 a[62:63], v19 offset:4608
    v_mfma_f32_16x16x32_bf16 v[64:67], a[24:27], a[0:3], v[64:67]
    ds_read_b64_tr_b16 a[64:65], v18 offset:12288
    v_mfma_f32_16x16x32_bf16 v[68:71], a[24:27], a[4:7], v[68:71]
    ds_read_b64_tr_b16 a[66:67], v18 offset:12800
    v_mfma_f32_16x16x32_bf16 v[72:75], a[24:27], a[8:11], v[72:75]
    ds_read_b64_tr_b16 a[68:69], v19 offset:12288
    v_mfma_f32_16x16x32_bf16 v[76:79], a[24:27], a[12:15], v[76:79]
    ds_read_b64_tr_b16 a[70:71], v19 offset:12800
    v_mfma_f32_16x16x32_bf16 v[92:95], a[28:31], a[12:15], v[92:95]
    ds_read_b64_tr_b16 a[72:73], v18 offset:20480
    v_mfma_f32_16x16x32_bf16 v[88:91], a[28:31], a[8:11], v[88:91]
    ds_read_b64_tr_b16 a[74:75], v18 offset:20992
    v_mfma_f32_16x16x32_bf16 v[84:87], a[28:31], a[4:7], v[84:87]
    ds_read_b64_tr_b16 a[76:77], v19 offset:20480
    v_mfma_f32_16x16x32_bf16 v[80:83], a[28:31], a[0:3], v[80:83]
    ds_read_b64_tr_b16 a[78:79], v19 offset:20992
    v_mfma_f32_16x16x32_bf16 v[96:99], a[0:3], a[32:35], v[96:99]
    s_add_u32 s28, s28, 40960
    v_mfma_f32_16x16x32_bf16 v[100:103], a[4:7], a[32:35], v[100:103]
    s_cmp_eq_u32 s28, 122880
    v_mfma_f32_16x16x32_bf16 v[104:107], a[8:11], a[32:35], v[104:107]
    s_cselect_b32 s28, 0, s28
    v_mfma_f32_16x16x32_bf16 v[108:111], a[12:15], a[32:35], v[108:111]
    v_mfma_f32_16x16x32_bf16 v[124:127], a[12:15], a[36:39], v[124:127]
    v_add_u32 v16, s28, v8
    v_mfma_f32_16x16x32_bf16 v[120:123], a[8:11], a[36:39], v[120:123]
    s_cmp_eq_u32 s29, 13
    s_cbranch_scc1 L_drain
L_drained:
    v_mfma_f32_16x16x32_bf16 v[116:119], a[4:7], a[36:39], v[116:119]
    v_mfma_f32_16x16x32_bf16 v[112:115], a[0:3], a[36:39], v[112:115]
    s_waitcnt lgkmcnt(0)
    v_mfma_f32_16x16x32_bf16 v[32:35], a[56:59], a[40:43], v[32:35]
    v_add_u32 v18, s28, v10
    v_add_u32 v19, s28, v11
    v_mfma_f32_16x16x32_bf16 v[36:39], a[56:59], a[44:47], v[36:39]
    s_barrier
    v_mfma_f32_16x16x32_bf16 v[40:43], a[56:59], a[48:51], v[40:43]
    ds_read_b64_tr_b16 a[16:17], v18 offset:0
    v_mfma_f32_16x16x32_bf16 v[44:47], a[56:59], a[52:55], v[44:47]
    ds_read_b64_tr_b16 a[18:19], v18 offset:512
    v_mfma_f32_16x16x32_bf16 v[60:63], a[60:63], a[52:55], v[60:63]
    ds_read_b128 a[0:3], v16 offset:0
    v_mfma_f32_16x16x32_bf16 v[56:59], a[60:63], a[48:51], v[56:59]
    ds_read_b128 a[4:7], v16 offset:2048
    v_mfma_f32_16x16x32_bf16 v[52:55], a[60:63], a[44:47], v[52:55]
    ds_read_b128 a[8:11], v16 offset:4096
    v_mfma_f32_16x16x32_bf16 v[48:51], a[60:63], a[40:43], v[48:51]
    ds_read_b128 a[12:15], v16 offset:6144
    v_mfma_f32_16x16x32_bf16 v[64:67], a[64:67], a[40:43], v[64:67]
    ds_read_b64_tr_b16 a[20:21], v19 offset:0
    v_mfma_f32_16x16x32_bf16 v[68:71], a[64:67], a[44:47], v[68:71]
    ds_read_b64_tr_b16 a[22:23], v19 offset:512
    v_mfma_f32_16x16x32_bf16 v[72:75], a[64:67], a[48:51], v[72:75]
    ds_read_b64_tr_b16 a[24:25], v18 offset:8192
    v_mfma_f32_16x16x32_bf16 v[76:79], a[64:67], a[52:55], v[76:79]
    ds_read_b64_tr_b16 a[26:27], v18 offset:8704
    v_mfma_f32_16x16x32_bf16 v[92:95], a[68:71], a[52:55], v[92:95]
    ds_read_b64_tr_b16 a[28:29], v19 offset:8192
    v_mfma_f32_16x16x32_bf16 v[88:91], a[68:71], a[48:51], v[88:91]
    ds_read_b64_tr_b16 a[30:31], v19 offset:8704
    v_mfma_f32_16x16x32_bf16 v[84:87], a[68:71], a[44:47], v[84:87]
    ds_read_b64_tr_b16 a[32:33], v18 offset:16384
    v_mfma_f32_16x16x32_bf16 v[80:83], a[68:71], a[40:43], v[80:83]
    ds_read_b64_tr_b16 a[34:35], v18 offset:16896
    v_mfma_f32_16x16x32_bf16 v[96:99], a[40:43], a[72:75], v[96:99]
    ds_read_b64_tr_b16 a[36:37], v19 offset:16384
    v_mfma_f32_16x16x32_bf16 v[100:103], a[44:47], a[72:75], v[100:103]
    ds_read_b64_tr_b16 a[38:39], v19 offset:16896
    v_mfma_f32_16x16x32_bf16 v[104:107], a[48:51], a[72:75], v[104:107]
    v_mfma_f32_16x16x32_bf16 v[108:111], a[52:55], a[72:75], v[108:111]
    v_add_u32 v17, s28, v9
    v_mfma_f32_16x16x32_bf16 v[124:127], a[52:55], a[76:79], v[124:127]
    v_mfma_f32_16x16x32_bf16 v[120:123], a[48:51], a[76:79], v[120:123]
    s_sub_u32 s29, s29, 1
    v_mfma_f32_16x16x32_bf16 v[116:119], a[44:47], a[76:79], v[116:119]
    s_cmp_lg_u32 s29, 0
    v_mfma_f32_16x16x32_bf16 v[112:115], a[40:43], a[76:79], v[112:115]
    s_cbranch_scc1 L_gemm_17
    v_lshrrev_b32 v2, 4, v0
    v_and_b32 v1, 15, v0
    s_lshl_b32 s27, s25, 7
    s_add_u32 s27, s27, 122880
    v_lshl_add_u32 v3, v2, 4, s27
    v_lshl_add_u32 v4, v1, 2, s27
    s_lshl_b32 s27, s26, 8
    s_add_u32 s27, s27, 123648
    v_lshl_add_u32 v5, v1, 2, s27
    v_lshl_add_u32 v6, v2, 4, s27
    v_mov_b32 v7, 124672
    s_waitcnt lgkmcnt(0)
    ds_read_b128 v[8:11], v3 offset:256
    ds_read_b128 v[12:15], v3 offset:320
    ds_read_b32 v16, v5 offset:0
    ds_read_b32 v17, v5 offset:512
    ds_read_b32 v18, v5 offset:64
    ds_read_b32 v19, v5 offset:576
    ds_read_b32 v20, v5 offset:128
    ds_read_b32 v21, v5 offset:640
    ds_read_b32 v22, v5 offset:192
    ds_read_b32 v23, v5 offset:704
    ds_read_b128 v[24:27], v3 offset:0
    ds_read_b128 v[28:31], v3 offset:64
    ds_read2_b32 v[4:5], v4 offset0:128 offset1:144
    ds_read_b32 v3, v7 offset:8
    ds_read_b32 v7, v7
    s_lshl_b32 s32, s25, 14
    s_lshl_b32 s31, s26, 13
    s_add_u32 s32, s32, s31
    s_lshl_b32 s30, s21, 4
    s_add_u32 s30, s30, s22
    s_lshl_b32 s31, s30, 14
    s_lshl_b32 s30, s30, 15
    s_add_u32 s30, s30, s32
    s_add_u32 s30, s30, 1048576
    s_add_u32 s33, s30, 4096
    s_lshl_b32 s32, s25, 13
    s_add_u32 s31, s31, s32
    s_lshl_b32 s32, s26, 12
    s_add_u32 s31, s31, s32
    s_add_u32 s31, s31, 9437184
    v_lshlrev_b32 v2, 4, v0
    s_and_b32 s27, s22, 1
    s_xor_b32 s27, s27, s25
    s_lshl_b32 s27, s27, 1
    s_add_u32 s27, s27, s26
    s_lshl_b32 s27, s27, 13
    v_add_u32 v1, s27, v2
    s_waitcnt lgkmcnt(5)
    v_pk_fma_f32 v[64:65], v[8:9], v[16:17], v[64:65] op_sel_hi:[1,0,1]
    v_pk_fma_f32 v[66:67], v[10:11], v[16:17], v[66:67] op_sel_hi:[1,0,1]
    v_pk_fma_f32 v[68:69], v[8:9], v[18:19], v[68:69] op_sel_hi:[1,0,1]
    v_pk_fma_f32 v[70:71], v[10:11], v[18:19], v[70:71] op_sel_hi:[1,0,1]
    v_pk_fma_f32 v[80:81], v[12:13], v[16:17], v[80:81] op_sel_hi:[1,0,1]
    v_pk_fma_f32 v[82:83], v[14:15], v[16:17], v[82:83] op_sel_hi:[1,0,1]
    v_pk_fma_f32 v[84:85], v[12:13], v[18:19], v[84:85] op_sel_hi:[1,0,1]
    v_pk_fma_f32 v[86:87], v[14:15], v[18:19], v[86:87] op_sel_hi:[1,0,1]
    v_pk_mul_f32 v[64:65], v[64:65], v[16:17] op_sel:[0,1] op_sel_hi:[1,1]
    v_pk_mul_f32 v[66:67], v[66:67], v[16:17] op_sel:[0,1] op_sel_hi:[1,1]
    v_pk_mul_f32 v[68:69], v[68:69], v[18:19] op_sel:[0,1] op_sel_hi:[1,1]
    v_pk_mul_f32 v[70:71], v[70:71], v[18:19] op_sel:[0,1] op_sel_hi:[1,1]
    v_pk_mul_f32 v[80:81], v[80:81], v[16:17] op_sel:[0,1] op_sel_hi:[1,1]
    v_pk_mul_f32 v[82:83], v[82:83], v[16:17] op_sel:[0,1] op_sel_hi:[1,1]
    v_pk_mul_f32 v[84:85], v[84:85], v[18:19] op_sel:[0,1] op_sel_hi:[1,1]
    v_pk_mul_f32 v[86:87], v[86:87], v[18:19] op_sel:[0,1] op_sel_hi:[1,1]
    v_cvt_pk_bf16_f32 v64, v64, v65
    v_cvt_pk_bf16_f32 v65, v66, v67
    v_cvt_pk_bf16_f32 v66, v68, v69
    v_cvt_pk_bf16_f32 v67, v70, v71
    v_cvt_pk_bf16_f32 v80, v80, v81
    v_cvt_pk_bf16_f32 v81, v82, v83
    v_cvt_pk_bf16_f32 v82, v84, v85
    v_cvt_pk_bf16_f32 v83, v86, v87
    s_nop 0
    v_permlane16_swap_b32 v64, v66
    v_permlane16_swap_b32 v65, v67
    v_permlane16_swap_b32 v80, v82
    v_permlane16_swap_b32 v81, v83
    buffer_store_dwordx4 v[64:67], v2, s[12:15], s30 offen sc1
    buffer_store_dwordx4 v[80:83], v2, s[12:15], s30 offen offset:1024 sc1
    ds_read_b128 v[68:71], v6 offset:0
    ds_read_b128 v[84:87], v6 offset:512
    ds_write_b128 v1, v[64:67] offset:0
    ds_write_b128 v1, v[80:83] offset:1024
    v_pk_fma_f32 v[72:73], v[8:9], v[20:21], v[72:73] op_sel_hi:[1,0,1]
    v_pk_fma_f32 v[74:75], v[10:11], v[20:21], v[74:75] op_sel_hi:[1,0,1]
    v_pk_fma_f32 v[76:77], v[8:9], v[22:23], v[76:77] op_sel_hi:[1,0,1]
    v_pk_fma_f32 v[78:79], v[10:11], v[22:23], v[78:79] op_sel_hi:[1,0,1]
    v_pk_fma_f32 v[88:89], v[12:13], v[20:21], v[88:89] op_sel_hi:[1,0,1]
    v_pk_fma_f32 v[90:91], v[14:15], v[20:21], v[90:91] op_sel_hi:[1,0,1]
    v_pk_fma_f32 v[92:93], v[12:13], v[22:23], v[92:93] op_sel_hi:[1,0,1]
    v_pk_fma_f32 v[94:95], v[14:15], v[22:23], v[94:95] op_sel_hi:[1,0,1]
    v_pk_mul_f32 v[72:73], v[72:73], v[20:21] op_sel:[0,1] op_sel_hi:[1,1]
    v_pk_mul_f32 v[74:75], v[74:75], v[20:21] op_sel:[0,1] op_sel_hi:[1,1]
    v_pk_mul_f32 v[76:77], v[76:77], v[22:23] op_sel:[0,1] op_sel_hi:[1,1]
    v_pk_mul_f32 v[78:79], v[78:79], v[22:23] op_sel:[0,1] op_sel_hi:[1,1]
    v_pk_mul_f32 v[88:89], v[88:89], v[20:21] op_sel:[0,1] op_sel_hi:[1,1]
    v_pk_mul_f32 v[90:91], v[90:91], v[20:21] op_sel:[0,1] op_sel_hi:[1,1]
    v_pk_mul_f32 v[92:93], v[92:93], v[22:23] op_sel:[0,1] op_sel_hi:[1,1]
    v_pk_mul_f32 v[94:95], v[94:95], v[22:23] op_sel:[0,1] op_sel_hi:[1,1]
    v_cvt_pk_bf16_f32 v72, v72, v73
    v_cvt_pk_bf16_f32 v73, v74, v75
    v_cvt_pk_bf16_f32 v74, v76, v77
    v_cvt_pk_bf16_f32 v75, v78, v79
    v_cvt_pk_bf16_f32 v88, v88, v89
    v_cvt_pk_bf16_f32 v89, v90, v91
    v_cvt_pk_bf16_f32 v90, v92, v93
    v_cvt_pk_bf16_f32 v91, v94, v95
    s_nop 0
    v_permlane16_swap_b32 v72, v74
    v_permlane16_swap_b32 v73, v75
    v_permlane16_swap_b32 v88, v90
    v_permlane16_swap_b32 v89, v91
    buffer_store_dwordx4 v[72:75], v2, s[12:15], s33 offen sc1
    buffer_store_dwordx4 v[88:91], v2, s[12:15], s33 offen offset:1024 sc1
    ds_read_b128 v[76:79], v6 offset:64
    ds_read_b128 v[92:95], v6 offset:576
    ds_write_b128 v1, v[72:75] offset:4096
    ds_write_b128 v1, v[88:91] offset:5120
    v_mul_f32 v17, 0x3e8293ee, v17
    v_mul_f32 v19, 0x3e8293ee, v19
    v_mul_f32 v21, 0x3e8293ee, v21
    v_mul_f32 v23, 0x3e8293ee, v23
    s_waitcnt lgkmcnt(0)
    v_pk_fma_f32 v[96:97], v[68:69], v[4:5], v[96:97] op_sel_hi:[1,0,1]
    v_pk_fma_f32 v[98:99], v[70:71], v[4:5], v[98:99] op_sel_hi:[1,0,1]
    v_pk_fma_f32 v[112:113], v[68:69], v[4:5], v[112:113] op_sel:[0,1,0] op_sel_hi:[1,1,1]
    v_pk_fma_f32 v[114:115], v[70:71], v[4:5], v[114:115] op_sel:[0,1,0] op_sel_hi:[1,1,1]
    v_pk_mul_f32 v[96:97], v[96:97], v[84:85]
    v_pk_mul_f32 v[98:99], v[98:99], v[86:87]
    v_pk_mul_f32 v[112:113], v[112:113], v[84:85]
    v_pk_mul_f32 v[114:115], v[114:115], v[86:87]
    v_pk_fma_f32 v[100:101], v[76:77], v[4:5], v[100:101] op_sel_hi:[1,0,1]
    v_pk_fma_f32 v[102:103], v[78:79], v[4:5], v[102:103] op_sel_hi:[1,0,1]
    v_pk_fma_f32 v[116:117], v[76:77], v[4:5], v[116:117] op_sel:[0,1,0] op_sel_hi:[1,1,1]
    v_pk_fma_f32 v[118:119], v[78:79], v[4:5], v[118:119] op_sel:[0,1,0] op_sel_hi:[1,1,1]
    v_pk_mul_f32 v[100:101], v[100:101], v[92:93]
    v_pk_mul_f32 v[102:103], v[102:103], v[94:95]
    v_pk_mul_f32 v[116:117], v[116:117], v[92:93]
    v_pk_mul_f32 v[118:119], v[118:119], v[94:95]
    ds_read_b128 v[68:71], v6 offset:128
    ds_read_b128 v[84:87], v6 offset:640
    ds_read_b128 v[76:79], v6 offset:192
    ds_read_b128 v[92:95], v6 offset:704
    v_cvt_pk_bf16_f32 v96, v96, v97
    v_cvt_pk_bf16_f32 v97, v98, v99
    v_cvt_pk_bf16_f32 v98, v112, v113
    v_cvt_pk_bf16_f32 v99, v114, v115
    v_cvt_pk_bf16_f32 v100, v100, v101
    v_cvt_pk_bf16_f32 v101, v102, v103
    v_cvt_pk_bf16_f32 v102, v116, v117
    v_cvt_pk_bf16_f32 v103, v118, v119
    s_nop 0
    v_permlane16_swap_b32 v96, v98
    v_permlane16_swap_b32 v97, v99
    v_permlane16_swap_b32 v100, v102
    v_permlane16_swap_b32 v101, v103
    s_nop 0
    v_permlane32_swap_b32 v96, v98
    v_permlane32_swap_b32 v97, v99
    v_permlane32_swap_b32 v100, v102
    v_permlane32_swap_b32 v101, v103
    buffer_store_dwordx4 v[96:99], v2, s[12:15], s30 offen offset:2048 sc1
    buffer_store_dwordx4 v[100:103], v2, s[12:15], s30 offen offset:3072 sc1
    ds_write_b128 v1, v[96:99] offset:2048
    ds_write_b128 v1, v[100:103] offset:3072
    v_readfirstlane_b32 s23, v7
    v_readfirstlane_b32 s60, v3
    s_waitcnt lgkmcnt(0)
    v_pk_fma_f32 v[104:105], v[68:69], v[4:5], v[104:105] op_sel_hi:[1,0,1]
    v_pk_fma_f32 v[106:107], v[70:71], v[4:5], v[106:107] op_sel_hi:[1,0,1]
    v_pk_fma_f32 v[120:121], v[68:69], v[4:5], v[120:121] op_sel:[0,1,0] op_sel_hi:[1,1,1]
    v_pk_fma_f32 v[122:123], v[70:71], v[4:5], v[122:123] op_sel:[0,1,0] op_sel_hi:[1,1,1]
    v_pk_mul_f32 v[104:105], v[104:105], v[84:85]
    v_pk_mul_f32 v[106:107], v[106:107], v[86:87]
    v_pk_mul_f32 v[120:121], v[120:121], v[84:85]
    v_pk_mul_f32 v[122:123], v[122:123], v[86:87]
    v_pk_fma_f32 v[108:109], v[76:77], v[4:5], v[108:109] op_sel_hi:[1,0,1]
    v_pk_fma_f32 v[110:111], v[78:79], v[4:5], v[110:111] op_sel_hi:[1,0,1]
    v_pk_fma_f32 v[124:125], v[76:77], v[4:5], v[124:125] op_sel:[0,1,0] op_sel_hi:[1,1,1]
    v_pk_fma_f32 v[126:127], v[78:79], v[4:5], v[126:127] op_sel:[0,1,0] op_sel_hi:[1,1,1]
    v_pk_mul_f32 v[108:109], v[108:109], v[92:93]
    v_pk_mul_f32 v[110:111], v[110:111], v[94:95]
    v_pk_mul_f32 v[124:125], v[124:125], v[92:93]
    v_pk_mul_f32 v[126:127], v[126:127], v[94:95]
    v_cvt_pk_bf16_f32 v104, v104, v105
    v_cvt_pk_bf16_f32 v105, v106, v107
    v_cvt_pk_bf16_f32 v106, v120, v121
    v_cvt_pk_bf16_f32 v107, v122, v123
    v_cvt_pk_bf16_f32 v108, v108, v109
    v_cvt_pk_bf16_f32 v109, v110, v111
    v_cvt_pk_bf16_f32 v110, v124, v125
    v_cvt_pk_bf16_f32 v111, v126, v127
    s_nop 0
    v_permlane16_swap_b32 v104, v106
    v_permlane16_swap_b32 v105, v107
    v_permlane16_swap_b32 v108, v110
    v_permlane16_swap_b32 v109, v111
    s_nop 0
    v_permlane32_swap_b32 v104, v106
    v_permlane32_swap_b32 v105, v107
    v_permlane32_swap_b32 v108, v110
    v_permlane32_swap_b32 v109, v111
    buffer_store_dwordx4 v[104:107], v2, s[12:15], s33 offen offset:2048 sc1
    buffer_store_dwordx4 v[108:111], v2, s[12:15], s33 offen offset:3072 sc1
    ds_write_b128 v1, v[104:107] offset:6144
    ds_write_b128 v1, v[108:111] offset:7168
    v_pk_fma_f32 v[32:33], v[24:25], v[16:17], v[32:33] op_sel_hi:[1,0,1]
    v_pk_fma_f32 v[34:35], v[26:27], v[16:17], v[34:35] op_sel_hi:[1,0,1]
    v_pk_fma_f32 v[36:37], v[24:25], v[18:19], v[36:37] op_sel_hi:[1,0,1]
    v_pk_fma_f32 v[38:39], v[26:27], v[18:19], v[38:39] op_sel_hi:[1,0,1]
    v_pk_fma_f32 v[48:49], v[28:29], v[16:17], v[48:49] op_sel_hi:[1,0,1]
    v_pk_fma_f32 v[50:51], v[30:31], v[16:17], v[50:51] op_sel_hi:[1,0,1]
    v_pk_fma_f32 v[52:53], v[28:29], v[18:19], v[52:53] op_sel_hi:[1,0,1]
    v_pk_fma_f32 v[54:55], v[30:31], v[18:19], v[54:55] op_sel_hi:[1,0,1]
    v_pk_mul_f32 v[32:33], v[32:33], v[16:17] op_sel:[0,1] op_sel_hi:[1,1]
    v_pk_mul_f32 v[34:35], v[34:35], v[16:17] op_sel:[0,1] op_sel_hi:[1,1]
    v_pk_mul_f32 v[36:37], v[36:37], v[18:19] op_sel:[0,1] op_sel_hi:[1,1]
    v_pk_mul_f32 v[38:39], v[38:39], v[18:19] op_sel:[0,1] op_sel_hi:[1,1]
    v_pk_mul_f32 v[48:49], v[48:49], v[16:17] op_sel:[0,1] op_sel_hi:[1,1]
    v_pk_mul_f32 v[50:51], v[50:51], v[16:17] op_sel:[0,1] op_sel_hi:[1,1]
    v_pk_mul_f32 v[52:53], v[52:53], v[18:19] op_sel:[0,1] op_sel_hi:[1,1]
    v_pk_mul_f32 v[54:55], v[54:55], v[18:19] op_sel:[0,1] op_sel_hi:[1,1]
    v_cvt_pk_bf16_f32 v32, v32, v33
    v_cvt_pk_bf16_f32 v33, v34, v35
    v_cvt_pk_bf16_f32 v34, v36, v37
    v_cvt_pk_bf16_f32 v35, v38, v39
    v_cvt_pk_bf16_f32 v48, v48, v49
    v_cvt_pk_bf16_f32 v49, v50, v51
    v_cvt_pk_bf16_f32 v50, v52, v53
    v_cvt_pk_bf16_f32 v51, v54, v55
    s_nop 0
    v_permlane16_swap_b32 v32, v34
    v_permlane16_swap_b32 v33, v35
    v_permlane16_swap_b32 v48, v50
    v_permlane16_swap_b32 v49, v51
    v_pk_fma_f32 v[40:41], v[24:25], v[20:21], v[40:41] op_sel_hi:[1,0,1]
    v_pk_fma_f32 v[42:43], v[26:27], v[20:21], v[42:43] op_sel_hi:[1,0,1]
    v_pk_fma_f32 v[44:45], v[24:25], v[22:23], v[44:45] op_sel_hi:[1,0,1]
    v_pk_fma_f32 v[46:47], v[26:27], v[22:23], v[46:47] op_sel_hi:[1,0,1]
    v_pk_fma_f32 v[56:57], v[28:29], v[20:21], v[56:57] op_sel_hi:[1,0,1]
    v_pk_fma_f32 v[58:59], v[30:31], v[20:21], v[58:59] op_sel_hi:[1,0,1]
    v_pk_fma_f32 v[60:61], v[28:29], v[22:23], v[60:61] op_sel_hi:[1,0,1]
    v_pk_fma_f32 v[62:63], v[30:31], v[22:23], v[62:63] op_sel_hi:[1,0,1]
    v_pk_mul_f32 v[40:41], v[40:41], v[20:21] op_sel:[0,1] op_sel_hi:[1,1]
    v_pk_mul_f32 v[42:43], v[42:43], v[20:21] op_sel:[0,1] op_sel_hi:[1,1]
    v_pk_mul_f32 v[44:45], v[44:45], v[22:23] op_sel:[0,1] op_sel_hi:[1,1]
    v_pk_mul_f32 v[46:47], v[46:47], v[22:23] op_sel:[0,1] op_sel_hi:[1,1]
    v_pk_mul_f32 v[56:57], v[56:57], v[20:21] op_sel:[0,1] op_sel_hi:[1,1]
    v_pk_mul_f32 v[58:59], v[58:59], v[20:21] op_sel:[0,1] op_sel_hi:[1,1]
    v_pk_mul_f32 v[60:61], v[60:61], v[22:23] op_sel:[0,1] op_sel_hi:[1,1]
    v_pk_mul_f32 v[62:63], v[62:63], v[22:23] op_sel:[0,1] op_sel_hi:[1,1]
    v_cvt_pk_bf16_f32 v40, v40, v41
    v_cvt_pk_bf16_f32 v41, v42, v43
    v_cvt_pk_bf16_f32 v42, v44, v45
    v_cvt_pk_bf16_f32 v43, v46, v47
    v_cvt_pk_bf16_f32 v56, v56, v57
    v_cvt_pk_bf16_f32 v57, v58, v59
    v_cvt_pk_bf16_f32 v58, v60, v61
    v_cvt_pk_bf16_f32 v59, v62, v63
    s_nop 0
    v_permlane16_swap_b32 v40, v42
    v_permlane16_swap_b32 v41, v43
    v_permlane16_swap_b32 v56, v58
    v_permlane16_swap_b32 v57, v59
    s_and_b32 s27, s22, 1
    s_cmp_eq_u32 s27, s25
    s_cselect_b32 s31, 0x7ffffff0, s31
    s_cselect_b32 s27, 0, 8192
    s_lshl_b32 s32, s26, 12
    s_add_u32 s27, s27, s32
    s_add_u32 s27, s27, 49152
    v_add_u32 v3, s27, v2
    s_cmp_lg_u32 s60, 0
    s_cbranch_scc1 L_18
    buffer_store_dwordx4 v[32:35], v2, s[12:15], s31 offen offset:0
    buffer_store_dwordx4 v[48:51], v2, s[12:15], s31 offen offset:1024
    buffer_store_dwordx4 v[40:43], v2, s[12:15], s31 offen offset:2048
    buffer_store_dwordx4 v[56:59], v2, s[12:15], s31 offen offset:3072
    s_branch L_19
L_18:
    buffer_store_dwordx4 v[32:35], v2, s[12:15], s31 offen offset:0 sc1
    buffer_store_dwordx4 v[48:51], v2, s[12:15], s31 offen offset:1024 sc1
    buffer_store_dwordx4 v[40:43], v2, s[12:15], s31 offen offset:2048 sc1
    buffer_store_dwordx4 v[56:59], v2, s[12:15], s31 offen offset:3072 sc1
L_19:
    ds_write_b128 v3, v[32:35] offset:0
    ds_write_b128 v3, v[48:51] offset:1024
    ds_write_b128 v3, v[40:43] offset:2048
    ds_write_b128 v3, v[56:59] offset:3072
L_join:
    v_lshlrev_b32 v2, 4, v0
    v_lshlrev_b32 v1, 2, v0
    s_cmp_ge_u32 s2, 224
    s_cselect_b32 s61, 224, s2
    v_mov_b32 v3, 0x3f803f80
    v_and_b32 v4, 6, v0
    v_cmp_eq_u32 vcc, 0, v4
    v_cmp_eq_u32 s[28:29], 4, v4
    v_and_b32 v4, 1, v0
    v_cndmask_b32 v28, 0, v3, vcc
    v_cndmask_b32 v29, 0, v3, vcc
    v_cndmask_b32 v30, 0, v3, s[28:29]
    v_cndmask_b32 v31, 0, v3, s[28:29]
    v_cmp_eq_u32 vcc, 1, v4
    v_mov_b32 v3, 0x44444444
    v_mov_b32 v4, 0xeeeeeeee
    v_cndmask_b32 v15, v3, v4, vcc
    s_and_b32 s38, s2, 7
    s_lshl_b32 s38, s38, 2
    s_lshr_b32 s39, s2, 6
    s_add_u32 s38, s38, s39
    s_bfe_u32 s39, s2, 0x30003
    s_mov_b32 s16, s78
    s_mov_b32 s17, s79
    s_mov_b32 s18, 0x700000
    s_mov_b32 s19, 0x20000
    s_cmp_ge_u32 s61, 224
    s_cselect_b32 s18, 0, s18
    s_mov_b32 s64, s74
    s_mov_b32 s65, s75
    s_mov_b32 s66, 0x700000
    s_mov_b32 s67, 0x20000
    s_cmp_ge_u32 s61, 224
    s_cselect_b32 s66, 0, s66
    s_mov_b32 s68, s76
    s_mov_b32 s69, s77
    s_mov_b32 s70, 0x700000
    s_mov_b32 s71, 0x20000
    s_cmp_ge_u32 s61, 224
    s_cselect_b32 s70, 0, s70
    s_lshl_b32 s47, s20, 12
    s_and_b32 s44, s61, 3
    s_lshl_b32 s44, s44, 3
    s_add_u32 s44, s44, s20
    s_mul_i32 s44, s44, 229376
    s_lshr_b32 s48, s61, 2
    s_lshl_b32 s48, s48, 7
    s_add_u32 s44, s44, s48
    s_lshl_b32 s45, s61, 15
    s_add_u32 s45, s45, s47
    s_lshl_b32 s46, s39, 3
    s_add_u32 s46, s46, s20
    s_lshl_b32 s46, s46, 15
    s_add_u32 s46, s46, 17825792
    v_lshrrev_b32 v3, 3, v0
    v_mul_u32_u24 v9, 7168, v3
    v_and_b32 v3, 6, v3
    v_and_b32 v4, 7, v0
    v_xor_b32 v4, v3, v4
    v_lshl_add_u32 v9, v4, 4, v9
    v_lshrrev_b32 v3, 2, v0
    v_and_b32 v4, 3, v0
    v_lshlrev_b32 v4, 3, v4
    v_lshl_add_u32 v8, v3, 7, v4
    v_bfe_u32 v3, v0, 3, 2
    v_lshl_add_u32 v8, v3, 5, v8
    s_add_u32 s48, s47, 65536
    v_add_u32 v8, s48, v8
    v_add_u32 v10, s48, v1
    s_and_b32 s49, s20, 1
    s_lshl_b32 s49, s49, 8
    s_add_u32 s48, s49, 65536
    v_add_u32 v11, s48, v1
    s_lshl_b32 s48, s61, 9
    s_add_u32 s48, s48, s49
    s_add_u32 s48, s48, 294912
    s_cmp_ge_u32 s20, 2
    s_cselect_b32 s48, 0x7ffffff0, s48
    v_bfe_u32 v3, v0, 2, 2
    v_lshrrev_b32 v12, 5, v0
    v_lshl_add_u32 v12, v12, 3, v3
    v_lshlrev_b32 v12, 11, v12
    v_bfe_u32 v3, v0, 4, 1
    v_lshl_add_u32 v12, v3, 5, v12
    s_lshl_b32 s49, s20, 8
    s_add_u32 s49, s49, 131072
    v_add3_u32 v12, v12, v4, s49
    v_lshrrev_b32 v3, 5, v0
    v_bfe_u32 v14, v0, 2, 1
    v_lshlrev_b32 v14, 5, v14
    v_lshl_add_u32 v14, v3, 4, v14
    v_add_u32 v14, 98304, v14
    s_lshl_b32 s49, s61, 2
    s_add_u32 s49, s49, 278528
    s_lshl_b32 s55, s2, 2
    s_add_u32 s55, s55, 282624
    s_cmp_lg_u32 s20, 0
    s_cselect_b32 s49, 0x7ffffff0, s49
    s_cselect_b32 s55, 0x7ffffff0, s55
    s_min_u32 s51, s61, 223
    s_and_b32 s51, s51, 0xfc
    s_lshl_b32 s50, s51, 2
    s_add_u32 s50, s50, 278528
    s_lshl_b32 s51, s51, 9
    s_and_b32 s52, s61, 3
    s_lshl_b32 s52, s52, 6
    s_add_u32 s51, s51, s52
    s_add_u32 s51, s51, 294912
    s_and_b32 s53, s2, 7
    s_lshl_b32 s53, s53, 12
    s_lshl_b32 s52, s20, 9
    s_add_u32 s53, s53, s52
    s_add_u32 s53, s53, 229376
    s_cmp_ge_u32 s61, 224
    s_cselect_b32 s53, 0x7ffffff0, s53
    v_cmp_eq_u32 vcc, 0, v0
    v_mov_b32 v3, 0x7ffffff0
    v_mov_b32 v6, s23
    v_cndmask_b32 v3, v3, 0, vcc
    s_lshl_b32 s30, s21, 19
    s_and_b32 s27, s22, 1
    s_lshl_b32 s28, s27, 14
    s_add_u32 s30, s30, s28
    s_lshl_b32 s33, s20, 11
    s_add_u32 s30, s30, s33
    s_add_u32 s30, s30, 1048576
    s_lshl_b32 s36, s21, 4
    s_and_b32 s28, s22, 14
    s_add_u32 s36, s36, s28
    s_lshr_b32 s28, s20, 2
    s_add_u32 s36, s36, s28
    s_lshl_b32 s36, s36, 14
    s_lshl_b32 s28, s27, 13
    s_add_u32 s36, s36, s28
    s_and_b32 s35, s20, 3
    s_lshl_b32 s35, s35, 11
    s_add_u32 s36, s36, s35
    s_add_u32 s36, s36, 9437184
    s_lshr_b32 s37, s20, 2
    s_xor_b32 s37, s37, s27
    s_add_u32 s35, s35, 49152
    s_lshl_b32 s28, s21, 6
    v_and_b32 v7, 15, v0
    v_lshl_add_u32 v13, v7, 2, s28
    s_lshl_b32 s29, s22, 2
    s_add_u32 s29, s29, s28
    s_add_u32 s29, s29, 270336
    s_mov_b32 s28, 270336
    s_waitcnt vmcnt(0) lgkmcnt(0)
    s_barrier
    s_cmp_eq_u32 s20, 0
    s_cbranch_scc0 L_20
    s_cmp_lg_u32 s60, 0
    s_cbranch_scc1 L_21
    buffer_store_dword v6, v3, s[12:15], s29 offen
    s_branch L_22
L_21:
    buffer_store_dword v6, v3, s[12:15], s29 offen sc1
L_22:
L_20:
    s_cmp_eq_u32 s20, 0
    s_cbranch_scc0 L_23
    buffer_load_dword v7, v13, s[12:15], s28 offen sc1
L_23:
    v_mov_b32 v122, 124672
    ds_read_b32 v122, v122 offset:4
    v_add_u32 v4, s35, v2
    ds_read_b128 v[16:19], v4
    ds_read_b128 v[20:23], v4 offset:1024
    s_and_b32 s35, s61, 3
    s_lshl_b32 s35, s35, 9
    s_lshl_b32 s52, s20, 6
    s_add_u32 s35, s35, s52
    s_add_u32 s35, s35, 131072
    v_lshrrev_b32 v120, 4, v0
    v_lshl_add_u32 v120, v120, 4, s35
    v_mov_b32 v121, 133120
    v_bfe_u32 v5, v0, 2, 2
    v_cmp_eq_u32 vcc, 0, v5
    s_nop 1
    v_cndmask_b32 v4, v121, v120, vcc
    ds_read_b128 a[112:115], v4
    v_cmp_eq_u32 vcc, 1, v5
    s_nop 1
    v_cndmask_b32 v4, v121, v120, vcc
    ds_read_b128 a[116:119], v4
    v_cmp_eq_u32 vcc, 2, v5
    s_nop 1
    v_cndmask_b32 v4, v121, v120, vcc
    ds_read_b128 a[120:123], v4
    v_cmp_eq_u32 vcc, 3, v5
    s_nop 1
    v_cndmask_b32 v4, v121, v120, vcc
    ds_read_b128 a[124:127], v4
    s_waitcnt lgkmcnt(0)
    v_readfirstlane_b32 s62, v122
    s_cmp_eq_u32 s20, 0
    s_cbranch_scc0 L_24
    s_waitcnt vmcnt(0)
    s_mov_b32 s3, 300000
L_spin_25:
    v_cmp_ne_u32 vcc, s23, v7
    s_nop 1
    s_cmp_eq_u64 vcc, 0
    s_cbranch_scc1 L_ok_26
    buffer_load_dword v7, v13, s[12:15], s28 offen sc1
    s_waitcnt vmcnt(0)
    s_sub_u32 s3, s3, 1
    s_cmp_lg_u32 s3, 0
    s_cbranch_scc1 L_spin_25
    s_endpgm
L_ok_26:
L_24:
    s_barrier
    s_cmp_eq_u32 s37, 0
    s_cbranch_scc1 L_27
    buffer_load_dwordx4 v[16:19], v2, s[12:15], s36 offen sc1
    buffer_load_dwordx4 v[20:23], v2, s[12:15], s36 offen offset:1024 sc1
L_27:
    s_add_u32 m0, s33, 16384
    s_cmp_ge_u32 s22, 1
    s_cselect_b32 s34, 0, 32768
    s_add_u32 s34, s34, s30
    s_add_u32 s34, s34, 0
    buffer_load_dwordx4 v2, s[12:15], s34 offen offset:0 sc1 lds
    buffer_load_dwordx4 v2, s[12:15], s34 offen offset:1024 sc1 lds
    s_add_u32 m0, s33, 32768
    s_cmp_ge_u32 s22, 2
    s_cselect_b32 s34, 0, 32768
    s_add_u32 s34, s34, s30
    s_add_u32 s34, s34, 32768
    buffer_load_dwordx4 v2, s[12:15], s34 offen offset:0 sc1 lds
    buffer_load_dwordx4 v2, s[12:15], s34 offen offset:1024 sc1 lds
    s_waitcnt vmcnt(4)
    ds_read_b128 v[104:107], v2
    ds_read_b128 v[108:111], v2 offset:1024
    v_mov_b32 v24, 0
    v_mov_b32 v25, 0
    v_mov_b32 v26, 0
    v_mov_b32 v27, 0
    s_waitcnt lgkmcnt(1)
    v_mfma_f32_32x32x16_bf16 v[32:47], v[104:107], v[16:19], 0
    s_waitcnt lgkmcnt(0)
    v_mfma_f32_32x32x16_bf16 v[32:47], v[108:111], v[20:23], v[32:47]
    ds_read_b128 v[104:107], v2 offset:4096
    ds_read_b128 v[108:111], v2 offset:5120
    ds_read_b128 v[112:115], v2 offset:2048
    s_nop 8
    v_max3_f32 v4, v32, v33, v34
    v_max3_f32 v4, v4, v35, v36
    v_max3_f32 v4, v4, v37, v38
    v_max3_f32 v4, v4, v39, v40
    v_max3_f32 v4, v4, v41, v42
    v_max3_f32 v4, v4, v43, v44
    v_max3_f32 v4, v4, v45, v46
    v_max_f32 v4, v4, v47
    v_mov_b32 v5, v4
    s_nop 1
    v_permlane32_swap_b32 v4, v5
    v_max_f32 v4, v4, v5
    v_sub_f32 v80, 0, v4
    v_mov_b32 v81, v80
    v_mov_b32 v82, v80
    v_mov_b32 v83, v80
    v_mov_b32 v84, v80
    v_mov_b32 v85, v80
    v_mov_b32 v86, v80
    v_mov_b32 v87, v80
    v_mov_b32 v88, v80
    v_mov_b32 v89, v80
    v_mov_b32 v90, v80
    v_mov_b32 v91, v80
    v_mov_b32 v92, v80
    v_mov_b32 v93, v80
    v_mov_b32 v94, v80
    v_mov_b32 v95, v80
    v_pk_add_f32 v[32:33], v[32:33], v[80:81]
    v_pk_add_f32 v[34:35], v[34:35], v[80:81]
    v_pk_add_f32 v[36:37], v[36:37], v[80:81]
    v_pk_add_f32 v[38:39], v[38:39], v[80:81]
    v_pk_add_f32 v[40:41], v[40:41], v[80:81]
    v_pk_add_f32 v[42:43], v[42:43], v[80:81]
    v_pk_add_f32 v[44:45], v[44:45], v[80:81]
    v_pk_add_f32 v[46:47], v[46:47], v[80:81]
    s_waitcnt lgkmcnt(1)
    v_mfma_f32_32x32x16_bf16 v[48:63], v[104:107], v[16:19], v[80:95]
    v_exp_f32 v32, v32
    v_exp_f32 v33, v33
    v_exp_f32 v34, v34
    v_exp_f32 v35, v35
    v_mfma_f32_32x32x16_bf16 v[48:63], v[108:111], v[20:23], v[48:63]
    ds_read_b128 v[104:107], v2 offset:8192
    ds_read_b128 v[108:111], v2 offset:9216
    v_exp_f32 v36, v36
    v_exp_f32 v37, v37
    v_exp_f32 v38, v38
    v_exp_f32 v39, v39
    s_waitcnt lgkmcnt(2)
    v_exp_f32 v40, v40
    v_exp_f32 v41, v41
    s_setprio 2
    ds_read_b128 v[116:119], v2 offset:3072
    v_cvt_pk_bf16_f32 v96, v32, v33
    v_cvt_pk_bf16_f32 v97, v34, v35
    v_cvt_pk_bf16_f32 v98, v36, v37
    v_cvt_pk_bf16_f32 v99, v38, v39
    v_exp_f32 v42, v42
    v_exp_f32 v43, v43
    v_mfma_f32_32x32x16_bf16 v[64:79], v[112:115], v[96:99], 0
    ds_read_b128 v[112:115], v2 offset:6144
    v_exp_f32 v44, v44
    v_exp_f32 v45, v45
    v_exp_f32 v46, v46
    v_exp_f32 v47, v47
    v_cvt_pk_bf16_f32 v100, v40, v41
    v_cvt_pk_bf16_f32 v101, v42, v43
    v_cvt_pk_bf16_f32 v102, v44, v45
    v_cvt_pk_bf16_f32 v103, v46, v47
    s_waitcnt lgkmcnt(2)
    v_mfma_f32_32x32x16_bf16 v[32:47], v[104:107], v[16:19], v[80:95]
    v_exp_f32 v48, v48
    v_exp_f32 v49, v49
    v_exp_f32 v50, v50
    v_exp_f32 v51, v51
    v_mfma_f32_32x32x16_bf16 v[32:47], v[108:111], v[20:23], v[32:47]
    ds_read_b128 v[104:107], v2 offset:12288
    ds_read_b128 v[108:111], v2 offset:13312
    v_exp_f32 v52, v52
    v_exp_f32 v53, v53
    v_exp_f32 v54, v54
    v_exp_f32 v55, v55
    v_smfmac_f32_16x16x64_bf16 v[24:27], v[28:31], v[96:103], v15
    s_setprio 1
    s_waitcnt lgkmcnt(2)
    v_exp_f32 v56, v56
    v_exp_f32 v57, v57
    v_mfma_f32_32x32x16_bf16 v[64:79], v[116:119], v[100:103], v[64:79]
    ds_read_b128 v[116:119], v2 offset:7168
    v_cvt_pk_bf16_f32 v96, v48, v49
    v_cvt_pk_bf16_f32 v97, v50, v51
    v_cvt_pk_bf16_f32 v98, v52, v53
    v_cvt_pk_bf16_f32 v99, v54, v55
    v_exp_f32 v58, v58
    v_exp_f32 v59, v59
    v_mfma_f32_32x32x16_bf16 v[64:79], v[112:115], v[96:99], v[64:79]
    s_setprio 0
    ds_read_b128 v[112:115], v2 offset:10240
    v_exp_f32 v60, v60
    v_exp_f32 v61, v61
    v_exp_f32 v62, v62
    v_exp_f32 v63, v63
    v_cvt_pk_bf16_f32 v100, v56, v57
    v_cvt_pk_bf16_f32 v101, v58, v59
    v_cvt_pk_bf16_f32 v102, v60, v61
    v_cvt_pk_bf16_f32 v103, v62, v63
    s_waitcnt lgkmcnt(2)
    v_mfma_f32_32x32x16_bf16 v[48:63], v[104:107], v[16:19], v[80:95]
    v_exp_f32 v32, v32
    v_exp_f32 v33, v33
    v_exp_f32 v34, v34
    v_exp_f32 v35, v35
    v_mfma_f32_32x32x16_bf16 v[48:63], v[108:111], v[20:23], v[48:63]
    s_waitcnt vmcnt(2)
    s_barrier
    s_setprio 3
    ds_read_b128 v[104:107], v2 offset:16384
    ds_read_b128 v[108:111], v2 offset:17408
    v_exp_f32 v36, v36
    v_exp_f32 v37, v37
    v_exp_f32 v38, v38
    v_exp_f32 v39, v39
    v_smfmac_f32_16x16x64_bf16 v[24:27], v[28:31], v[96:103], v15
    s_waitcnt lgkmcnt(2)
    v_exp_f32 v40, v40
    v_exp_f32 v41, v41
    v_mfma_f32_32x32x16_bf16 v[64:79], v[116:119], v[100:103], v[64:79]
    ds_read_b128 v[116:119], v2 offset:11264
    s_add_u32 m0, s33, 49152
    s_cmp_ge_u32 s22, 3
    s_cselect_b32 s34, 0, 32768
    s_add_u32 s34, s34, s30
    s_add_u32 s34, s34, 65536
    buffer_load_dwordx4 v2, s[12:15], s34 offen offset:0 sc1 lds
    buffer_load_dwordx4 v2, s[12:15], s34 offen offset:1024 sc1 lds
    v_cvt_pk_bf16_f32 v96, v32, v33
    v_cvt_pk_bf16_f32 v97, v34, v35
    v_cvt_pk_bf16_f32 v98, v36, v37
    v_cvt_pk_bf16_f32 v99, v38, v39
    v_exp_f32 v42, v42
    v_exp_f32 v43, v43
    v_mfma_f32_32x32x16_bf16 v[64:79], v[112:115], v[96:99], v[64:79]
    ds_read_b128 v[112:115], v2 offset:14336
    v_exp_f32 v44, v44
    v_exp_f32 v45, v45
    v_exp_f32 v46, v46
    v_exp_f32 v47, v47
    v_cvt_pk_bf16_f32 v100, v40, v41
    v_cvt_pk_bf16_f32 v101, v42, v43
    v_cvt_pk_bf16_f32 v102, v44, v45
    v_cvt_pk_bf16_f32 v103, v46, v47
    s_waitcnt lgkmcnt(2)
    v_mfma_f32_32x32x16_bf16 v[32:47], v[104:107], v[16:19], v[80:95]
    v_exp_f32 v48, v48
    v_exp_f32 v49, v49
    v_exp_f32 v50, v50
    v_exp_f32 v51, v51
    v_mfma_f32_32x32x16_bf16 v[32:47], v[108:111], v[20:23], v[32:47]
    ds_read_b128 v[104:107], v2 offset:20480
    ds_read_b128 v[108:111], v2 offset:21504
    v_exp_f32 v52, v52
    v_exp_f32 v53, v53
    v_exp_f32 v54, v54
    v_exp_f32 v55, v55
    v_smfmac_f32_16x16x64_bf16 v[24:27], v[28:31], v[96:103], v15
    s_waitcnt lgkmcnt(2)
    v_exp_f32 v56, v56
    v_exp_f32 v57, v57
    v_mfma_f32_32x32x16_bf16 v[64:79], v[116:119], v[100:103], v[64:79]
    ds_read_b128 v[116:119], v2 offset:15360
    s_add_u32 m0, s47, 65536
    s_add_u32 s52, s44, 0
    buffer_load_dwordx4 v9, s[64:67], s52 offen nt lds
    v_cvt_pk_bf16_f32 v96, v48, v49
    v_cvt_pk_bf16_f32 v97, v50, v51
    v_cvt_pk_bf16_f32 v98, v52, v53
    v_cvt_pk_bf16_f32 v99, v54, v55
    v_exp_f32 v58, v58
    v_exp_f32 v59, v59
    v_mfma_f32_32x32x16_bf16 v[64:79], v[112:115], v[96:99], v[64:79]
    ds_read_b128 v[112:115], v2 offset:18432
    v_exp_f32 v60, v60
    v_exp_f32 v61, v61
    v_exp_f32 v62, v62
    v_exp_f32 v63, v63
    v_cvt_pk_bf16_f32 v100, v56, v57
    v_cvt_pk_bf16_f32 v101, v58, v59
    v_cvt_pk_bf16_f32 v102, v60, v61
    v_cvt_pk_bf16_f32 v103, v62, v63
    s_waitcnt lgkmcnt(2)
    v_mfma_f32_32x32x16_bf16 v[48:63], v[104:107], v[16:19], v[80:95]
    v_exp_f32 v32, v32
    v_exp_f32 v33, v33
    v_exp_f32 v34, v34
    v_exp_f32 v35, v35
    v_mfma_f32_32x32x16_bf16 v[48:63], v[108:111], v[20:23], v[48:63]
    ds_read_b128 v[104:107], v2 offset:24576
    ds_read_b128 v[108:111], v2 offset:25600
    v_exp_f32 v36, v36
    v_exp_f32 v37, v37
    v_exp_f32 v38, v38
    v_exp_f32 v39, v39
    v_smfmac_f32_16x16x64_bf16 v[24:27], v[28:31], v[96:103], v15
    s_waitcnt lgkmcnt(2)
    v_exp_f32 v40, v40
    v_exp_f32 v41, v41
    v_mfma_f32_32x32x16_bf16 v[64:79], v[116:119], v[100:103], v[64:79]
    s_setprio 2
    ds_read_b128 v[116:119], v2 offset:19456
    v_cvt_pk_bf16_f32 v96, v32, v33
    v_cvt_pk_bf16_f32 v97, v34, v35
    v_cvt_pk_bf16_f32 v98, v36, v37
    v_cvt_pk_bf16_f32 v99, v38, v39
    v_exp_f32 v42, v42
    v_exp_f32 v43, v43
    v_mfma_f32_32x32x16_bf16 v[64:79], v[112:115], v[96:99], v[64:79]
    ds_read_b128 v[112:115], v2 offset:22528
    v_exp_f32 v44, v44
    v_exp_f32 v45, v45
    v_exp_f32 v46, v46
    v_exp_f32 v47, v47
    v_cvt_pk_bf16_f32 v100, v40, v41
    v_cvt_pk_bf16_f32 v101, v42, v43
    v_cvt_pk_bf16_f32 v102, v44, v45
    v_cvt_pk_bf16_f32 v103, v46, v47
    s_waitcnt lgkmcnt(2)
    v_mfma_f32_32x32x16_bf16 v[32:47], v[104:107], v[16:19], v[80:95]
    v_exp_f32 v48, v48
    v_exp_f32 v49, v49
    v_exp_f32 v50, v50
    v_exp_f32 v51, v51
    v_mfma_f32_32x32x16_bf16 v[32:47], v[108:111], v[20:23], v[32:47]
    ds_read_b128 v[104:107], v2 offset:28672
    ds_read_b128 v[108:111], v2 offset:29696
    v_exp_f32 v52, v52
    v_exp_f32 v53, v53
    v_exp_f32 v54, v54
    v_exp_f32 v55, v55
    v_smfmac_f32_16x16x64_bf16 v[24:27], v[28:31], v[96:103], v15
    s_setprio 1
    s_waitcnt lgkmcnt(2)
    v_exp_f32 v56, v56
    v_exp_f32 v57, v57
    v_mfma_f32_32x32x16_bf16 v[64:79], v[116:119], v[100:103], v[64:79]
    ds_read_b128 v[116:119], v2 offset:23552
    s_add_u32 m0, s47, 66560
    s_add_u32 s52, s44, 57344
    buffer_load_dwordx4 v9, s[64:67], s52 offen nt lds
    v_cvt_pk_bf16_f32 v96, v48, v49
    v_cvt_pk_bf16_f32 v97, v50, v51
    v_cvt_pk_bf16_f32 v98, v52, v53
    v_cvt_pk_bf16_f32 v99, v54, v55
    v_exp_f32 v58, v58
    v_exp_f32 v59, v59
    v_mfma_f32_32x32x16_bf16 v[64:79], v[112:115], v[96:99], v[64:79]
    s_setprio 0
    ds_read_b128 v[112:115], v2 offset:26624
    v_exp_f32 v60, v60
    v_exp_f32 v61, v61
    v_exp_f32 v62, v62
    v_exp_f32 v63, v63
    v_cvt_pk_bf16_f32 v100, v56, v57
    v_cvt_pk_bf16_f32 v101, v58, v59
    v_cvt_pk_bf16_f32 v102, v60, v61
    v_cvt_pk_bf16_f32 v103, v62, v63
    s_waitcnt lgkmcnt(2)
    v_mfma_f32_32x32x16_bf16 v[48:63], v[104:107], v[16:19], v[80:95]
    v_exp_f32 v32, v32
    v_exp_f32 v33, v33
    v_exp_f32 v34, v34
    v_exp_f32 v35, v35
    v_mfma_f32_32x32x16_bf16 v[48:63], v[108:111], v[20:23], v[48:63]
    s_waitcnt vmcnt(4)
    s_barrier
    s_setprio 3
    ds_read_b128 v[104:107], v2 offset:32768
    ds_read_b128 v[108:111], v2 offset:33792
    v_exp_f32 v36, v36
    v_exp_f32 v37, v37
    v_exp_f32 v38, v38
    v_exp_f32 v39, v39
    v_smfmac_f32_16x16x64_bf16 v[24:27], v[28:31], v[96:103], v15
    s_waitcnt lgkmcnt(2)
    v_exp_f32 v40, v40
    v_exp_f32 v41, v41
    v_mfma_f32_32x32x16_bf16 v[64:79], v[116:119], v[100:103], v[64:79]
    ds_read_b128 v[116:119], v2 offset:27648
    s_add_u32 m0, s33, 0
    s_cmp_ge_u32 s22, 4
    s_cselect_b32 s34, 0, 32768
    s_add_u32 s34, s34, s30
    s_add_u32 s34, s34, 98304
    buffer_load_dwordx4 v2, s[12:15], s34 offen offset:0 sc1 lds
    buffer_load_dwordx4 v2, s[12:15], s34 offen offset:1024 sc1 lds
    v_cvt_pk_bf16_f32 v96, v32, v33
    v_cvt_pk_bf16_f32 v97, v34, v35
    v_cvt_pk_bf16_f32 v98, v36, v37
    v_cvt_pk_bf16_f32 v99, v38, v39
    v_exp_f32 v42, v42
    v_exp_f32 v43, v43
    v_mfma_f32_32x32x16_bf16 v[64:79], v[112:115], v[96:99], v[64:79]
    ds_read_b128 v[112:115], v2 offset:30720
    v_exp_f32 v44, v44
    v_exp_f32 v45, v45
    v_exp_f32 v46, v46
    v_exp_f32 v47, v47
    v_cvt_pk_bf16_f32 v100, v40, v41
    v_cvt_pk_bf16_f32 v101, v42, v43
    v_cvt_pk_bf16_f32 v102, v44, v45
    v_cvt_pk_bf16_f32 v103, v46, v47
    s_waitcnt lgkmcnt(2)
    v_mfma_f32_32x32x16_bf16 v[32:47], v[104:107], v[16:19], v[80:95]
    v_exp_f32 v48, v48
    v_exp_f32 v49, v49
    v_exp_f32 v50, v50
    v_exp_f32 v51, v51
    v_mfma_f32_32x32x16_bf16 v[32:47], v[108:111], v[20:23], v[32:47]
    ds_read_b128 v[104:107], v2 offset:36864
    ds_read_b128 v[108:111], v2 offset:37888
    v_exp_f32 v52, v52
    v_exp_f32 v53, v53
    v_exp_f32 v54, v54
    v_exp_f32 v55, v55
    v_smfmac_f32_16x16x64_bf16 v[24:27], v[28:31], v[96:103], v15
    s_waitcnt lgkmcnt(2)
    v_exp_f32 v56, v56
    v_exp_f32 v57, v57
    v_mfma_f32_32x32x16_bf16 v[64:79], v[116:119], v[100:103], v[64:79]
    ds_read_b128 v[116:119], v2 offset:31744
    s_add_u32 m0, s47, 67584
    s_add_u32 s52, s44, 114688
    buffer_load_dwordx4 v9, s[64:67], s52 offen nt lds
    v_cvt_pk_bf16_f32 v96, v48, v49
    v_cvt_pk_bf16_f32 v97, v50, v51
    v_cvt_pk_bf16_f32 v98, v52, v53
    v_cvt_pk_bf16_f32 v99, v54, v55
    v_exp_f32 v58, v58
    v_exp_f32 v59, v59
    v_mfma_f32_32x32x16_bf16 v[64:79], v[112:115], v[96:99], v[64:79]
    ds_read_b128 v[112:115], v2 offset:34816
    v_exp_f32 v60, v60
    v_exp_f32 v61, v61
    v_exp_f32 v62, v62
    v_exp_f32 v63, v63
    v_cvt_pk_bf16_f32 v100, v56, v57
    v_cvt_pk_bf16_f32 v101, v58, v59
    v_cvt_pk_bf16_f32 v102, v60, v61
    v_cvt_pk_bf16_f32 v103, v62, v63
    s_waitcnt lgkmcnt(2)
    v_mfma_f32_32x32x16_bf16 v[48:63], v[104:107], v[16:19], v[80:95]
    v_exp_f32 v32, v32
    v_exp_f32 v33, v33
    v_exp_f32 v34, v34
    v_exp_f32 v35, v35
    v_mfma_f32_32x32x16_bf16 v[48:63], v[108:111], v[20:23], v[48:63]
    ds_read_b128 v[104:107], v2 offset:40960
    ds_read_b128 v[108:111], v2 offset:41984
    v_exp_f32 v36, v36
    v_exp_f32 v37, v37
    v_exp_f32 v38, v38
    v_exp_f32 v39, v39
    v_smfmac_f32_16x16x64_bf16 v[24:27], v[28:31], v[96:103], v15
    s_waitcnt lgkmcnt(2)
    v_exp_f32 v40, v40
    v_exp_f32 v41, v41
    v_mfma_f32_32x32x16_bf16 v[64:79], v[116:119], v[100:103], v[64:79]
    s_setprio 2
    ds_read_b128 v[116:119], v2 offset:35840
    v_cvt_pk_bf16_f32 v96, v32, v33
    v_cvt_pk_bf16_f32 v97, v34, v35
    v_cvt_pk_bf16_f32 v98, v36, v37
    v_cvt_pk_bf16_f32 v99, v38, v39
    v_exp_f32 v42, v42
    v_exp_f32 v43, v43
    v_mfma_f32_32x32x16_bf16 v[64:79], v[112:115], v[96:99], v[64:79]
    ds_read_b128 v[112:115], v2 offset:38912
    v_exp_f32 v44, v44
    v_exp_f32 v45, v45
    v_exp_f32 v46, v46
    v_exp_f32 v47, v47
    v_cvt_pk_bf16_f32 v100, v40, v41
    v_cvt_pk_bf16_f32 v101, v42, v43
    v_cvt_pk_bf16_f32 v102, v44, v45
    v_cvt_pk_bf16_f32 v103, v46, v47
    s_waitcnt lgkmcnt(2)
    v_mfma_f32_32x32x16_bf16 v[32:47], v[104:107], v[16:19], v[80:95]
    v_exp_f32 v48, v48
    v_exp_f32 v49, v49
    v_exp_f32 v50, v50
    v_exp_f32 v51, v51
    v_mfma_f32_32x32x16_bf16 v[32:47], v[108:111], v[20:23], v[32:47]
    ds_read_b128 v[104:107], v2 offset:45056
    ds_read_b128 v[108:111], v2 offset:46080
    v_exp_f32 v52, v52
    v_exp_f32 v53, v53
    v_exp_f32 v54, v54
    v_exp_f32 v55, v55
    v_smfmac_f32_16x16x64_bf16 v[24:27], v[28:31], v[96:103], v15
    s_setprio 1
    s_waitcnt lgkmcnt(2)
    v_exp_f32 v56, v56
    v_exp_f32 v57, v57
    v_mfma_f32_32x32x16_bf16 v[64:79], v[116:119], v[100:103], v[64:79]
    ds_read_b128 v[116:119], v2 offset:39936
    s_add_u32 m0, s47, 68608
    s_add_u32 s52, s44, 172032
    buffer_load_dwordx4 v9, s[64:67], s52 offen nt lds
    v_cvt_pk_bf16_f32 v96, v48, v49
    v_cvt_pk_bf16_f32 v97, v50, v51
    v_cvt_pk_bf16_f32 v98, v52, v53
    v_cvt_pk_bf16_f32 v99, v54, v55
    v_exp_f32 v58, v58
    v_exp_f32 v59, v59
    v_mfma_f32_32x32x16_bf16 v[64:79], v[112:115], v[96:99], v[64:79]
    s_setprio 0
    ds_read_b128 v[112:115], v2 offset:43008
    v_exp_f32 v60, v60
    v_exp_f32 v61, v61
    v_exp_f32 v62, v62
    v_exp_f32 v63, v63
    v_cvt_pk_bf16_f32 v100, v56, v57
    v_cvt_pk_bf16_f32 v101, v58, v59
    v_cvt_pk_bf16_f32 v102, v60, v61
    v_cvt_pk_bf16_f32 v103, v62, v63
    s_waitcnt lgkmcnt(2)
    v_mfma_f32_32x32x16_bf16 v[48:63], v[104:107], v[16:19], v[80:95]
    v_exp_f32 v32, v32
    v_exp_f32 v33, v33
    v_exp_f32 v34, v34
    v_exp_f32 v35, v35
    v_mfma_f32_32x32x16_bf16 v[48:63], v[108:111], v[20:23], v[48:63]
    s_waitcnt vmcnt(6)
    s_barrier
    s_setprio 3
    ds_read_b128 v[104:107], v2 offset:49152
    ds_read_b128 v[108:111], v2 offset:50176
    v_exp_f32 v36, v36
    v_exp_f32 v37, v37
    v_exp_f32 v38, v38
    v_exp_f32 v39, v39
    v_smfmac_f32_16x16x64_bf16 v[24:27], v[28:31], v[96:103], v15
    s_waitcnt lgkmcnt(2)
    v_exp_f32 v40, v40
    v_exp_f32 v41, v41
    v_mfma_f32_32x32x16_bf16 v[64:79], v[116:119], v[100:103], v[64:79]
    ds_read_b128 v[116:119], v2 offset:44032
    s_add_u32 m0, s33, 16384
    s_cmp_ge_u32 s22, 5
    s_cselect_b32 s34, 0, 32768
    s_add_u32 s34, s34, s30
    s_add_u32 s34, s34, 131072
    buffer_load_dwordx4 v2, s[12:15], s34 offen offset:0 sc1 lds
    buffer_load_dwordx4 v2, s[12:15], s34 offen offset:1024 sc1 lds
    v_cvt_pk_bf16_f32 v96, v32, v33
    v_cvt_pk_bf16_f32 v97, v34, v35
    v_cvt_pk_bf16_f32 v98, v36, v37
    v_cvt_pk_bf16_f32 v99, v38, v39
    v_exp_f32 v42, v42
    v_exp_f32 v43, v43
    v_mfma_f32_32x32x16_bf16 v[64:79], v[112:115], v[96:99], v[64:79]
    ds_read_b128 v[112:115], v2 offset:47104
    v_exp_f32 v44, v44
    v_exp_f32 v45, v45
    v_exp_f32 v46, v46
    v_exp_f32 v47, v47
    v_cvt_pk_bf16_f32 v100, v40, v41
    v_cvt_pk_bf16_f32 v101, v42, v43
    v_cvt_pk_bf16_f32 v102, v44, v45
    v_cvt_pk_bf16_f32 v103, v46, v47
    s_waitcnt lgkmcnt(2)
    v_mfma_f32_32x32x16_bf16 v[32:47], v[104:107], v[16:19], v[80:95]
    v_exp_f32 v48, v48
    v_exp_f32 v49, v49
    v_exp_f32 v50, v50
    v_exp_f32 v51, v51
    v_mfma_f32_32x32x16_bf16 v[32:47], v[108:111], v[20:23], v[32:47]
    ds_read_b128 v[104:107], v2 offset:53248
    ds_read_b128 v[108:111], v2 offset:54272
    v_exp_f32 v52, v52
    v_exp_f32 v53, v53
    v_exp_f32 v54, v54
    v_exp_f32 v55, v55
    v_smfmac_f32_16x16x64_bf16 v[24:27], v[28:31], v[96:103], v15
    s_waitcnt lgkmcnt(2)
    v_exp_f32 v56, v56
    v_exp_f32 v57, v57
    v_mfma_f32_32x32x16_bf16 v[64:79], v[116:119], v[100:103], v[64:79]
    ds_read_b128 v[116:119], v2 offset:48128
    s_add_u32 m0, s47, 98304
    s_add_u32 s52, s44, 0
    buffer_load_dwordx4 v9, s[68:71], s52 offen nt lds
    v_cvt_pk_bf16_f32 v96, v48, v49
    v_cvt_pk_bf16_f32 v97, v50, v51
    v_cvt_pk_bf16_f32 v98, v52, v53
    v_cvt_pk_bf16_f32 v99, v54, v55
    v_exp_f32 v58, v58
    v_exp_f32 v59, v59
    v_mfma_f32_32x32x16_bf16 v[64:79], v[112:115], v[96:99], v[64:79]
    ds_read_b128 v[112:115], v2 offset:51200
    v_exp_f32 v60, v60
    v_exp_f32 v61, v61
    v_exp_f32 v62, v62
    v_exp_f32 v63, v63
    v_cvt_pk_bf16_f32 v100, v56, v57
    v_cvt_pk_bf16_f32 v101, v58, v59
    v_cvt_pk_bf16_f32 v102, v60, v61
    v_cvt_pk_bf16_f32 v103, v62, v63
    s_waitcnt lgkmcnt(2)
    v_mfma_f32_32x32x16_bf16 v[48:63], v[104:107], v[16:19], v[80:95]
    v_exp_f32 v32, v32
    v_exp_f32 v33, v33
    v_exp_f32 v34, v34
    v_exp_f32 v35, v35
    v_mfma_f32_32x32x16_bf16 v[48:63], v[108:111], v[20:23], v[48:63]
    ds_read_b128 v[104:107], v2 offset:57344
    ds_read_b128 v[108:111], v2 offset:58368
    v_exp_f32 v36, v36
    v_exp_f32 v37, v37
    v_exp_f32 v38, v38
    v_exp_f32 v39, v39
    v_smfmac_f32_16x16x64_bf16 v[24:27], v[28:31], v[96:103], v15
    s_waitcnt lgkmcnt(2)
    v_exp_f32 v40, v40
    v_exp_f32 v41, v41
    v_mfma_f32_32x32x16_bf16 v[64:79], v[116:119], v[100:103], v[64:79]
    s_setprio 2
    ds_read_b128 v[116:119], v2 offset:52224
    v_cvt_pk_bf16_f32 v96, v32, v33
    v_cvt_pk_bf16_f32 v97, v34, v35
    v_cvt_pk_bf16_f32 v98, v36, v37
    v_cvt_pk_bf16_f32 v99, v38, v39
    v_exp_f32 v42, v42
    v_exp_f32 v43, v43
    v_mfma_f32_32x32x16_bf16 v[64:79], v[112:115], v[96:99], v[64:79]
    ds_read_b128 v[112:115], v2 offset:55296
    v_exp_f32 v44, v44
    v_exp_f32 v45, v45
    v_exp_f32 v46, v46
    v_exp_f32 v47, v47
    v_cvt_pk_bf16_f32 v100, v40, v41
    v_cvt_pk_bf16_f32 v101, v42, v43
    v_cvt_pk_bf16_f32 v102, v44, v45
    v_cvt_pk_bf16_f32 v103, v46, v47
    s_waitcnt lgkmcnt(2)
    v_mfma_f32_32x32x16_bf16 v[32:47], v[104:107], v[16:19], v[80:95]
    v_exp_f32 v48, v48
    v_exp_f32 v49, v49
    v_exp_f32 v50, v50
    v_exp_f32 v51, v51
    v_mfma_f32_32x32x16_bf16 v[32:47], v[108:111], v[20:23], v[32:47]
    ds_read_b128 v[104:107], v2 offset:61440
    ds_read_b128 v[108:111], v2 offset:62464
    v_exp_f32 v52, v52
    v_exp_f32 v53, v53
    v_exp_f32 v54, v54
    v_exp_f32 v55, v55
    v_smfmac_f32_16x16x64_bf16 v[24:27], v[28:31], v[96:103], v15
    s_setprio 1
    s_waitcnt lgkmcnt(2)
    v_exp_f32 v56, v56
    v_exp_f32 v57, v57
    v_mfma_f32_32x32x16_bf16 v[64:79], v[116:119], v[100:103], v[64:79]
    ds_read_b128 v[116:119], v2 offset:56320
    s_add_u32 m0, s47, 99328
    s_add_u32 s52, s44, 57344
    buffer_load_dwordx4 v9, s[68:71], s52 offen nt lds
    v_cvt_pk_bf16_f32 v96, v48, v49
    v_cvt_pk_bf16_f32 v97, v50, v51
    v_cvt_pk_bf16_f32 v98, v52, v53
    v_cvt_pk_bf16_f32 v99, v54, v55
    v_exp_f32 v58, v58
    v_exp_f32 v59, v59
    v_mfma_f32_32x32x16_bf16 v[64:79], v[112:115], v[96:99], v[64:79]
    s_setprio 0
    ds_read_b128 v[112:115], v2 offset:59392
    v_exp_f32 v60, v60
    v_exp_f32 v61, v61
    v_exp_f32 v62, v62
    v_exp_f32 v63, v63
    v_cvt_pk_bf16_f32 v100, v56, v57
    v_cvt_pk_bf16_f32 v101, v58, v59
    v_cvt_pk_bf16_f32 v102, v60, v61
    v_cvt_pk_bf16_f32 v103, v62, v63
    s_waitcnt lgkmcnt(2)
    v_mfma_f32_32x32x16_bf16 v[48:63], v[104:107], v[16:19], v[80:95]
    v_exp_f32 v32, v32
    v_exp_f32 v33, v33
    v_exp_f32 v34, v34
    v_exp_f32 v35, v35
    v_mfma_f32_32x32x16_bf16 v[48:63], v[108:111], v[20:23], v[48:63]
    s_waitcnt vmcnt(6)
    s_barrier
    s_setprio 3
    ds_read_b128 v[104:107], v2 offset:0
    ds_read_b128 v[108:111], v2 offset:1024
    v_exp_f32 v36, v36
    v_exp_f32 v37, v37
    v_exp_f32 v38, v38
    v_exp_f32 v39, v39
    v_smfmac_f32_16x16x64_bf16 v[24:27], v[28:31], v[96:103], v15
    s_waitcnt lgkmcnt(2)
    v_exp_f32 v40, v40
    v_exp_f32 v41, v41
    v_mfma_f32_32x32x16_bf16 v[64:79], v[116:119], v[100:103], v[64:79]
    ds_read_b128 v[116:119], v2 offset:60416
    s_add_u32 m0, s33, 32768
    s_cmp_ge_u32 s22, 6
    s_cselect_b32 s34, 0, 32768
    s_add_u32 s34, s34, s30
    s_add_u32 s34, s34, 163840
    buffer_load_dwordx4 v2, s[12:15], s34 offen offset:0 sc1 lds
    buffer_load_dwordx4 v2, s[12:15], s34 offen offset:1024 sc1 lds
    v_cvt_pk_bf16_f32 v96, v32, v33
    v_cvt_pk_bf16_f32 v97, v34, v35
    v_cvt_pk_bf16_f32 v98, v36, v37
    v_cvt_pk_bf16_f32 v99, v38, v39
    v_exp_f32 v42, v42
    v_exp_f32 v43, v43
    v_mfma_f32_32x32x16_bf16 v[64:79], v[112:115], v[96:99], v[64:79]
    ds_read_b128 v[112:115], v2 offset:63488
    v_exp_f32 v44, v44
    v_exp_f32 v45, v45
    v_exp_f32 v46, v46
    v_exp_f32 v47, v47
    v_cvt_pk_bf16_f32 v100, v40, v41
    v_cvt_pk_bf16_f32 v101, v42, v43
    v_cvt_pk_bf16_f32 v102, v44, v45
    v_cvt_pk_bf16_f32 v103, v46, v47
    s_waitcnt lgkmcnt(2)
    v_mfma_f32_32x32x16_bf16 v[32:47], v[104:107], v[16:19], v[80:95]
    v_exp_f32 v48, v48
    v_exp_f32 v49, v49
    v_exp_f32 v50, v50
    v_exp_f32 v51, v51
    v_mfma_f32_32x32x16_bf16 v[32:47], v[108:111], v[20:23], v[32:47]
    ds_read_b128 v[104:107], v2 offset:4096
    ds_read_b128 v[108:111], v2 offset:5120
    v_exp_f32 v52, v52
    v_exp_f32 v53, v53
    v_exp_f32 v54, v54
    v_exp_f32 v55, v55
    v_smfmac_f32_16x16x64_bf16 v[24:27], v[28:31], v[96:103], v15
    s_waitcnt lgkmcnt(2)
    v_exp_f32 v56, v56
    v_exp_f32 v57, v57
    v_mfma_f32_32x32x16_bf16 v[64:79], v[116:119], v[100:103], v[64:79]
    ds_read_b128 v[116:119], v2 offset:64512
    s_add_u32 m0, s47, 100352
    s_add_u32 s52, s44, 114688
    buffer_load_dwordx4 v9, s[68:71], s52 offen nt lds
    v_cvt_pk_bf16_f32 v96, v48, v49
    v_cvt_pk_bf16_f32 v97, v50, v51
    v_cvt_pk_bf16_f32 v98, v52, v53
    v_cvt_pk_bf16_f32 v99, v54, v55
    v_exp_f32 v58, v58
    v_exp_f32 v59, v59
    v_mfma_f32_32x32x16_bf16 v[64:79], v[112:115], v[96:99], v[64:79]
    ds_read_b128 v[112:115], v2 offset:2048
    v_exp_f32 v60, v60
    v_exp_f32 v61, v61
    v_exp_f32 v62, v62
    v_exp_f32 v63, v63
    v_cvt_pk_bf16_f32 v100, v56, v57
    v_cvt_pk_bf16_f32 v101, v58, v59
    v_cvt_pk_bf16_f32 v102, v60, v61
    v_cvt_pk_bf16_f32 v103, v62, v63
    s_waitcnt lgkmcnt(2)
    v_mfma_f32_32x32x16_bf16 v[48:63], v[104:107], v[16:19], v[80:95]
    v_exp_f32 v32, v32
    v_exp_f32 v33, v33
    v_exp_f32 v34, v34
    v_exp_f32 v35, v35
    v_mfma_f32_32x32x16_bf16 v[48:63], v[108:111], v[20:23], v[48:63]
    ds_read_b128 v[104:107], v2 offset:8192
    ds_read_b128 v[108:111], v2 offset:9216
    v_exp_f32 v36, v36
    v_exp_f32 v37, v37
    v_exp_f32 v38, v38
    v_exp_f32 v39, v39
    v_smfmac_f32_16x16x64_bf16 v[24:27], v[28:31], v[96:103], v15
    s_waitcnt lgkmcnt(2)
    v_exp_f32 v40, v40
    v_exp_f32 v41, v41
    v_mfma_f32_32x32x16_bf16 v[64:79], v[116:119], v[100:103], v[64:79]
    s_setprio 2
    ds_read_b128 v[116:119], v2 offset:3072
    v_cvt_pk_bf16_f32 v96, v32, v33
    v_cvt_pk_bf16_f32 v97, v34, v35
    v_cvt_pk_bf16_f32 v98, v36, v37
    v_cvt_pk_bf16_f32 v99, v38, v39
    v_exp_f32 v42, v42
    v_exp_f32 v43, v43
    v_mfma_f32_32x32x16_bf16 v[64:79], v[112:115], v[96:99], v[64:79]
    ds_read_b128 v[112:115], v2 offset:6144
    v_exp_f32 v44, v44
    v_exp_f32 v45, v45
    v_exp_f32 v46, v46
    v_exp_f32 v47, v47
    v_cvt_pk_bf16_f32 v100, v40, v41
    v_cvt_pk_bf16_f32 v101, v42, v43
    v_cvt_pk_bf16_f32 v102, v44, v45
    v_cvt_pk_bf16_f32 v103, v46, v47
    s_waitcnt lgkmcnt(2)
    v_mfma_f32_32x32x16_bf16 v[32:47], v[104:107], v[16:19], v[80:95]
    v_exp_f32 v48, v48
    v_exp_f32 v49, v49
    v_exp_f32 v50, v50
    v_exp_f32 v51, v51
    v_mfma_f32_32x32x16_bf16 v[32:47], v[108:111], v[20:23], v[32:47]
    ds_read_b128 v[104:107], v2 offset:12288
    ds_read_b128 v[108:111], v2 offset:13312
    v_exp_f32 v52, v52
    v_exp_f32 v53, v53
    v_exp_f32 v54, v54
    v_exp_f32 v55, v55
    v_smfmac_f32_16x16x64_bf16 v[24:27], v[28:31], v[96:103], v15
    s_setprio 1
    s_waitcnt lgkmcnt(2)
    v_exp_f32 v56, v56
    v_exp_f32 v57, v57
    v_mfma_f32_32x32x16_bf16 v[64:79], v[116:119], v[100:103], v[64:79]
    ds_read_b128 v[116:119], v2 offset:7168
    s_add_u32 m0, s47, 101376
    s_add_u32 s52, s44, 172032
    buffer_load_dwordx4 v9, s[68:71], s52 offen nt lds
    v_cvt_pk_bf16_f32 v96, v48, v49
    v_cvt_pk_bf16_f32 v97, v50, v51
    v_cvt_pk_bf16_f32 v98, v52, v53
    v_cvt_pk_bf16_f32 v99, v54, v55
    v_exp_f32 v58, v58
    v_exp_f32 v59, v59
    v_mfma_f32_32x32x16_bf16 v[64:79], v[112:115], v[96:99], v[64:79]
    s_setprio 0
    ds_read_b128 v[112:115], v2 offset:10240
    v_exp_f32 v60, v60
    v_exp_f32 v61, v61
    v_exp_f32 v62, v62
    v_exp_f32 v63, v63
    v_cvt_pk_bf16_f32 v100, v56, v57
    v_cvt_pk_bf16_f32 v101, v58, v59
    v_cvt_pk_bf16_f32 v102, v60, v61
    v_cvt_pk_bf16_f32 v103, v62, v63
    s_waitcnt lgkmcnt(2)
    v_mfma_f32_32x32x16_bf16 v[48:63], v[104:107], v[16:19], v[80:95]
    v_exp_f32 v32, v32
    v_exp_f32 v33, v33
    v_exp_f32 v34, v34
    v_exp_f32 v35, v35
    v_mfma_f32_32x32x16_bf16 v[48:63], v[108:111], v[20:23], v[48:63]
    s_waitcnt vmcnt(6)
    s_barrier
    s_setprio 3
    ds_read_b128 v[104:107], v2 offset:16384
    ds_read_b128 v[108:111], v2 offset:17408
    v_exp_f32 v36, v36
    v_exp_f32 v37, v37
    v_exp_f32 v38, v38
    v_exp_f32 v39, v39
    v_smfmac_f32_16x16x64_bf16 v[24:27], v[28:31], v[96:103], v15
    s_waitcnt lgkmcnt(2)
    v_exp_f32 v40, v40
    v_exp_f32 v41, v41
    v_mfma_f32_32x32x16_bf16 v[64:79], v[116:119], v[100:103], v[64:79]
    ds_read_b128 v[116:119], v2 offset:11264
    s_add_u32 m0, s33, 49152
    s_cmp_ge_u32 s22, 7
    s_cselect_b32 s34, 0, 32768
    s_add_u32 s34, s34, s30
    s_add_u32 s34, s34, 196608
    buffer_load_dwordx4 v2, s[12:15], s34 offen offset:0 sc1 lds
    buffer_load_dwordx4 v2, s[12:15], s34 offen offset:1024 sc1 lds
    v_cvt_pk_bf16_f32 v96, v32, v33
    v_cvt_pk_bf16_f32 v97, v34, v35
    v_cvt_pk_bf16_f32 v98, v36, v37
    v_cvt_pk_bf16_f32 v99, v38, v39
    v_exp_f32 v42, v42
    v_exp_f32 v43, v43
    v_mfma_f32_32x32x16_bf16 v[64:79], v[112:115], v[96:99], v[64:79]
    ds_read_b128 v[112:115], v2 offset:14336
    v_exp_f32 v44, v44
    v_exp_f32 v45, v45
    v_exp_f32 v46, v46
    v_exp_f32 v47, v47
    v_cvt_pk_bf16_f32 v100, v40, v41
    v_cvt_pk_bf16_f32 v101, v42, v43
    v_cvt_pk_bf16_f32 v102, v44, v45
    v_cvt_pk_bf16_f32 v103, v46, v47
    s_waitcnt lgkmcnt(2)
    v_mfma_f32_32x32x16_bf16 v[32:47], v[104:107], v[16:19], v[80:95]
    v_exp_f32 v48, v48
    v_exp_f32 v49, v49
    v_exp_f32 v50, v50
    v_exp_f32 v51, v51
    v_mfma_f32_32x32x16_bf16 v[32:47], v[108:111], v[20:23], v[32:47]
    ds_read_b128 v[104:107], v2 offset:20480
    ds_read_b128 v[108:111], v2 offset:21504
    v_exp_f32 v52, v52
    v_exp_f32 v53, v53
    v_exp_f32 v54, v54
    v_exp_f32 v55, v55
    v_smfmac_f32_16x16x64_bf16 v[24:27], v[28:31], v[96:103], v15
    s_waitcnt lgkmcnt(2)
    v_exp_f32 v56, v56
    v_exp_f32 v57, v57
    v_mfma_f32_32x32x16_bf16 v[64:79], v[116:119], v[100:103], v[64:79]
    ds_read_b128 v[116:119], v2 offset:15360
    s_add_u32 m0, s47, 131072
    s_nop 0
    buffer_load_dwordx4 v2, s[16:19], s45 offen offset:0 nt lds
    v_cvt_pk_bf16_f32 v96, v48, v49
    v_cvt_pk_bf16_f32 v97, v50, v51
    v_cvt_pk_bf16_f32 v98, v52, v53
    v_cvt_pk_bf16_f32 v99, v54, v55
    v_exp_f32 v58, v58
    v_exp_f32 v59, v59
    v_mfma_f32_32x32x16_bf16 v[64:79], v[112:115], v[96:99], v[64:79]
    ds_read_b128 v[112:115], v2 offset:18432
    v_exp_f32 v60, v60
    v_exp_f32 v61, v61
    v_exp_f32 v62, v62
    v_exp_f32 v63, v63
    v_cvt_pk_bf16_f32 v100, v56, v57
    v_cvt_pk_bf16_f32 v101, v58, v59
    v_cvt_pk_bf16_f32 v102, v60, v61
    v_cvt_pk_bf16_f32 v103, v62, v63
    s_waitcnt lgkmcnt(2)
    v_mfma_f32_32x32x16_bf16 v[48:63], v[104:107], v[16:19], v[80:95]
    v_exp_f32 v32, v32
    v_exp_f32 v33, v33
    v_exp_f32 v34, v34
    v_exp_f32 v35, v35
    v_mfma_f32_32x32x16_bf16 v[48:63], v[108:111], v[20:23], v[48:63]
    ds_read_b128 v[104:107], v2 offset:24576
    ds_read_b128 v[108:111], v2 offset:25600
    v_exp_f32 v36, v36
    v_exp_f32 v37, v37
    v_exp_f32 v38, v38
    v_exp_f32 v39, v39
    v_smfmac_f32_16x16x64_bf16 v[24:27], v[28:31], v[96:103], v15
    s_waitcnt lgkmcnt(2)
    v_exp_f32 v40, v40
    v_exp_f32 v41, v41
    v_mfma_f32_32x32x16_bf16 v[64:79], v[116:119], v[100:103], v[64:79]
    s_setprio 2
    ds_read_b128 v[116:119], v2 offset:19456
    v_cvt_pk_bf16_f32 v96, v32, v33
    v_cvt_pk_bf16_f32 v97, v34, v35
    v_cvt_pk_bf16_f32 v98, v36, v37
    v_cvt_pk_bf16_f32 v99, v38, v39
    v_exp_f32 v42, v42
    v_exp_f32 v43, v43
    v_mfma_f32_32x32x16_bf16 v[64:79], v[112:115], v[96:99], v[64:79]
    ds_read_b128 v[112:115], v2 offset:22528
    v_exp_f32 v44, v44
    v_exp_f32 v45, v45
    v_exp_f32 v46, v46
    v_exp_f32 v47, v47
    v_cvt_pk_bf16_f32 v100, v40, v41
    v_cvt_pk_bf16_f32 v101, v42, v43
    v_cvt_pk_bf16_f32 v102, v44, v45
    v_cvt_pk_bf16_f32 v103, v46, v47
    s_waitcnt lgkmcnt(2)
    v_mfma_f32_32x32x16_bf16 v[32:47], v[104:107], v[16:19], v[80:95]
    v_exp_f32 v48, v48
    v_exp_f32 v49, v49
    v_exp_f32 v50, v50
    v_exp_f32 v51, v51
    v_mfma_f32_32x32x16_bf16 v[32:47], v[108:111], v[20:23], v[32:47]
    ds_read_b128 v[104:107], v2 offset:28672
    ds_read_b128 v[108:111], v2 offset:29696
    v_exp_f32 v52, v52
    v_exp_f32 v53, v53
    v_exp_f32 v54, v54
    v_exp_f32 v55, v55
    v_smfmac_f32_16x16x64_bf16 v[24:27], v[28:31], v[96:103], v15
    s_setprio 1
    s_waitcnt lgkmcnt(2)
    v_exp_f32 v56, v56
    v_exp_f32 v57, v57
    v_mfma_f32_32x32x16_bf16 v[64:79], v[116:119], v[100:103], v[64:79]
    ds_read_b128 v[116:119], v2 offset:23552
    s_add_u32 m0, s47, 131072
    s_nop 0
    buffer_load_dwordx4 v2, s[16:19], s45 offen offset:1024 nt lds
    v_cvt_pk_bf16_f32 v96, v48, v49
    v_cvt_pk_bf16_f32 v97, v50, v51
    v_cvt_pk_bf16_f32 v98, v52, v53
    v_cvt_pk_bf16_f32 v99, v54, v55
    v_exp_f32 v58, v58
    v_exp_f32 v59, v59
    v_mfma_f32_32x32x16_bf16 v[64:79], v[112:115], v[96:99], v[64:79]
    s_setprio 0
    ds_read_b128 v[112:115], v2 offset:26624
    v_exp_f32 v60, v60
    v_exp_f32 v61, v61
    v_exp_f32 v62, v62
    v_exp_f32 v63, v63
    v_cvt_pk_bf16_f32 v100, v56, v57
    v_cvt_pk_bf16_f32 v101, v58, v59
    v_cvt_pk_bf16_f32 v102, v60, v61
    v_cvt_pk_bf16_f32 v103, v62, v63
    s_waitcnt lgkmcnt(2)
    v_mfma_f32_32x32x16_bf16 v[48:63], v[104:107], v[16:19], v[80:95]
    v_exp_f32 v32, v32
    v_exp_f32 v33, v33
    v_exp_f32 v34, v34
    v_exp_f32 v35, v35
    v_mfma_f32_32x32x16_bf16 v[48:63], v[108:111], v[20:23], v[48:63]
    s_waitcnt vmcnt(6)
    s_barrier
    s_setprio 3
    ds_read_b128 v[104:107], v2 offset:32768
    ds_read_b128 v[108:111], v2 offset:33792
    v_exp_f32 v36, v36
    v_exp_f32 v37, v37
    v_exp_f32 v38, v38
    v_exp_f32 v39, v39
    v_smfmac_f32_16x16x64_bf16 v[24:27], v[28:31], v[96:103], v15
    s_waitcnt lgkmcnt(2)
    v_exp_f32 v40, v40
    v_exp_f32 v41, v41
    v_mfma_f32_32x32x16_bf16 v[64:79], v[116:119], v[100:103], v[64:79]
    ds_read_b128 v[116:119], v2 offset:27648
    s_add_u32 m0, s33, 0
    s_cmp_ge_u32 s22, 8
    s_cselect_b32 s34, 0, 32768
    s_add_u32 s34, s34, s30
    s_add_u32 s34, s34, 229376
    buffer_load_dwordx4 v2, s[12:15], s34 offen offset:0 sc1 lds
    buffer_load_dwordx4 v2, s[12:15], s34 offen offset:1024 sc1 lds
    v_cvt_pk_bf16_f32 v96, v32, v33
    v_cvt_pk_bf16_f32 v97, v34, v35
    v_cvt_pk_bf16_f32 v98, v36, v37
    v_cvt_pk_bf16_f32 v99, v38, v39
    v_exp_f32 v42, v42
    v_exp_f32 v43, v43
    v_mfma_f32_32x32x16_bf16 v[64:79], v[112:115], v[96:99], v[64:79]
    ds_read_b128 v[112:115], v2 offset:30720
    v_exp_f32 v44, v44
    v_exp_f32 v45, v45
    v_exp_f32 v46, v46
    v_exp_f32 v47, v47
    v_cvt_pk_bf16_f32 v100, v40, v41
    v_cvt_pk_bf16_f32 v101, v42, v43
    v_cvt_pk_bf16_f32 v102, v44, v45
    v_cvt_pk_bf16_f32 v103, v46, v47
    s_waitcnt lgkmcnt(2)
    v_mfma_f32_32x32x16_bf16 v[32:47], v[104:107], v[16:19], v[80:95]
    v_exp_f32 v48, v48
    v_exp_f32 v49, v49
    v_exp_f32 v50, v50
    v_exp_f32 v51, v51
    v_mfma_f32_32x32x16_bf16 v[32:47], v[108:111], v[20:23], v[32:47]
    ds_read_b128 v[104:107], v2 offset:36864
    ds_read_b128 v[108:111], v2 offset:37888
    v_exp_f32 v52, v52
    v_exp_f32 v53, v53
    v_exp_f32 v54, v54
    v_exp_f32 v55, v55
    v_smfmac_f32_16x16x64_bf16 v[24:27], v[28:31], v[96:103], v15
    s_waitcnt lgkmcnt(2)
    v_exp_f32 v56, v56
    v_exp_f32 v57, v57
    v_mfma_f32_32x32x16_bf16 v[64:79], v[116:119], v[100:103], v[64:79]
    ds_read_b128 v[116:119], v2 offset:31744
    s_add_u32 m0, s47, 131072
    s_nop 0
    buffer_load_dwordx4 v2, s[16:19], s45 offen offset:2048 nt lds
    v_cvt_pk_bf16_f32 v96, v48, v49
    v_cvt_pk_bf16_f32 v97, v50, v51
    v_cvt_pk_bf16_f32 v98, v52, v53
    v_cvt_pk_bf16_f32 v99, v54, v55
    v_exp_f32 v58, v58
    v_exp_f32 v59, v59
    v_mfma_f32_32x32x16_bf16 v[64:79], v[112:115], v[96:99], v[64:79]
    ds_read_b128 v[112:115], v2 offset:34816
    v_exp_f32 v60, v60
    v_exp_f32 v61, v61
    v_exp_f32 v62, v62
    v_exp_f32 v63, v63
    v_cvt_pk_bf16_f32 v100, v56, v57
    v_cvt_pk_bf16_f32 v101, v58, v59
    v_cvt_pk_bf16_f32 v102, v60, v61
    v_cvt_pk_bf16_f32 v103, v62, v63
    s_waitcnt lgkmcnt(2)
    v_mfma_f32_32x32x16_bf16 v[48:63], v[104:107], v[16:19], v[80:95]
    v_exp_f32 v32, v32
    v_exp_f32 v33, v33
    v_exp_f32 v34, v34
    v_exp_f32 v35, v35
    v_mfma_f32_32x32x16_bf16 v[48:63], v[108:111], v[20:23], v[48:63]
    ds_read_b128 v[104:107], v2 offset:40960
    ds_read_b128 v[108:111], v2 offset:41984
    v_exp_f32 v36, v36
    v_exp_f32 v37, v37
    v_exp_f32 v38, v38
    v_exp_f32 v39, v39
    v_smfmac_f32_16x16x64_bf16 v[24:27], v[28:31], v[96:103], v15
    s_waitcnt lgkmcnt(2)
    v_exp_f32 v40, v40
    v_exp_f32 v41, v41
    v_mfma_f32_32x32x16_bf16 v[64:79], v[116:119], v[100:103], v[64:79]
    s_setprio 2
    ds_read_b128 v[116:119], v2 offset:35840
    v_cvt_pk_bf16_f32 v96, v32, v33
    v_cvt_pk_bf16_f32 v97, v34, v35
    v_cvt_pk_bf16_f32 v98, v36, v37
    v_cvt_pk_bf16_f32 v99, v38, v39
    v_exp_f32 v42, v42
    v_exp_f32 v43, v43
    v_mfma_f32_32x32x16_bf16 v[64:79], v[112:115], v[96:99], v[64:79]
    ds_read_b128 v[112:115], v2 offset:38912
    v_exp_f32 v44, v44
    v_exp_f32 v45, v45
    v_exp_f32 v46, v46
    v_exp_f32 v47, v47
    v_cvt_pk_bf16_f32 v100, v40, v41
    v_cvt_pk_bf16_f32 v101, v42, v43
    v_cvt_pk_bf16_f32 v102, v44, v45
    v_cvt_pk_bf16_f32 v103, v46, v47
    s_waitcnt lgkmcnt(2)
    v_mfma_f32_32x32x16_bf16 v[32:47], v[104:107], v[16:19], v[80:95]
    v_exp_f32 v48, v48
    v_exp_f32 v49, v49
    v_exp_f32 v50, v50
    v_exp_f32 v51, v51
    v_mfma_f32_32x32x16_bf16 v[32:47], v[108:111], v[20:23], v[32:47]
    ds_read_b128 v[104:107], v2 offset:45056
    ds_read_b128 v[108:111], v2 offset:46080
    v_exp_f32 v52, v52
    v_exp_f32 v53, v53
    v_exp_f32 v54, v54
    v_exp_f32 v55, v55
    v_smfmac_f32_16x16x64_bf16 v[24:27], v[28:31], v[96:103], v15
    s_setprio 1
    s_waitcnt lgkmcnt(2)
    v_exp_f32 v56, v56
    v_exp_f32 v57, v57
    v_mfma_f32_32x32x16_bf16 v[64:79], v[116:119], v[100:103], v[64:79]
    ds_read_b128 v[116:119], v2 offset:39936
    s_add_u32 m0, s47, 131072
    s_nop 0
    buffer_load_dwordx4 v2, s[16:19], s45 offen offset:3072 nt lds
    v_cvt_pk_bf16_f32 v96, v48, v49
    v_cvt_pk_bf16_f32 v97, v50, v51
    v_cvt_pk_bf16_f32 v98, v52, v53
    v_cvt_pk_bf16_f32 v99, v54, v55
    v_exp_f32 v58, v58
    v_exp_f32 v59, v59
    v_mfma_f32_32x32x16_bf16 v[64:79], v[112:115], v[96:99], v[64:79]
    s_setprio 0
    ds_read_b128 v[112:115], v2 offset:43008
    v_exp_f32 v60, v60
    v_exp_f32 v61, v61
    v_exp_f32 v62, v62
    v_exp_f32 v63, v63
    v_cvt_pk_bf16_f32 v100, v56, v57
    v_cvt_pk_bf16_f32 v101, v58, v59
    v_cvt_pk_bf16_f32 v102, v60, v61
    v_cvt_pk_bf16_f32 v103, v62, v63
    s_waitcnt lgkmcnt(2)
    v_mfma_f32_32x32x16_bf16 v[48:63], v[104:107], v[16:19], v[80:95]
    v_exp_f32 v32, v32
    v_exp_f32 v33, v33
    v_exp_f32 v34, v34
    v_exp_f32 v35, v35
    v_mfma_f32_32x32x16_bf16 v[48:63], v[108:111], v[20:23], v[48:63]
    s_waitcnt vmcnt(6)
    s_barrier
    s_setprio 3
    ds_read_b128 v[104:107], v2 offset:49152
    ds_read_b128 v[108:111], v2 offset:50176
    ds_read_b64_tr_b16 a[80:81], v8 offset:0
    ds_read_b64_tr_b16 a[82:83], v8 offset:2048
    ds_read_b64_tr_b16 a[96:97], v8 offset:32768
    ds_read_b64_tr_b16 a[98:99], v8 offset:34816
    v_exp_f32 v36, v36
    v_exp_f32 v37, v37
    v_exp_f32 v38, v38
    v_exp_f32 v39, v39
    v_smfmac_f32_16x16x64_bf16 v[24:27], v[28:31], v[96:103], v15
    s_waitcnt lgkmcnt(6)
    v_exp_f32 v40, v40
    v_exp_f32 v41, v41
    v_mfma_f32_32x32x16_bf16 v[64:79], v[116:119], v[100:103], v[64:79]
    ds_read_b128 v[116:119], v2 offset:44032
    s_add_u32 m0, s33, 16384
    s_cmp_ge_u32 s22, 9
    s_cselect_b32 s34, 0, 32768
    s_add_u32 s34, s34, s30
    s_add_u32 s34, s34, 262144
    buffer_load_dwordx4 v2, s[12:15], s34 offen offset:0 sc1 lds
    buffer_load_dwordx4 v2, s[12:15], s34 offen offset:1024 sc1 lds
    v_cvt_pk_bf16_f32 v96, v32, v33
    v_cvt_pk_bf16_f32 v97, v34, v35
    v_cvt_pk_bf16_f32 v98, v36, v37
    v_cvt_pk_bf16_f32 v99, v38, v39
    v_exp_f32 v42, v42
    v_exp_f32 v43, v43
    v_mfma_f32_32x32x16_bf16 v[64:79], v[112:115], v[96:99], v[64:79]
    ds_read_b128 v[112:115], v2 offset:47104
    v_xor_b32 v8, 32, v8
    ds_read_b64_tr_b16 a[84:85], v8 offset:0
    ds_read_b64_tr_b16 a[86:87], v8 offset:2048
    ds_read_b64_tr_b16 a[100:101], v8 offset:32768
    ds_read_b64_tr_b16 a[102:103], v8 offset:34816
    v_exp_f32 v44, v44
    v_exp_f32 v45, v45
    v_exp_f32 v46, v46
    v_exp_f32 v47, v47
    v_cvt_pk_bf16_f32 v100, v40, v41
    v_cvt_pk_bf16_f32 v101, v42, v43
    v_cvt_pk_bf16_f32 v102, v44, v45
    v_cvt_pk_bf16_f32 v103, v46, v47
    s_waitcnt lgkmcnt(10)
    v_mfma_f32_32x32x16_bf16 v[32:47], v[104:107], v[16:19], v[80:95]
    v_exp_f32 v48, v48
    v_exp_f32 v49, v49
    v_exp_f32 v50, v50
    v_exp_f32 v51, v51
    v_mfma_f32_32x32x16_bf16 v[32:47], v[108:111], v[20:23], v[32:47]
    ds_read_b128 v[104:107], v2 offset:53248
    ds_read_b128 v[108:111], v2 offset:54272
    v_xor_b32 v8, 96, v8
    ds_read_b64_tr_b16 a[88:89], v8 offset:0
    ds_read_b64_tr_b16 a[90:91], v8 offset:2048
    ds_read_b64_tr_b16 a[104:105], v8 offset:32768
    ds_read_b64_tr_b16 a[106:107], v8 offset:34816
    v_exp_f32 v52, v52
    v_exp_f32 v53, v53
    v_exp_f32 v54, v54
    v_exp_f32 v55, v55
    v_smfmac_f32_16x16x64_bf16 v[24:27], v[28:31], v[96:103], v15
    s_waitcnt lgkmcnt(10)
    v_exp_f32 v56, v56
    v_exp_f32 v57, v57
    v_mfma_f32_32x32x16_bf16 v[64:79], v[116:119], v[100:103], v[64:79]
    ds_read_b128 v[116:119], v2 offset:48128
    v_mfma_f32_16x16x32_bf16 v[120:123], a[112:115], a[80:83], 0
    v_mfma_f32_16x16x32_bf16 v[124:127], a[112:115], a[96:99], 0
    v_cvt_pk_bf16_f32 v96, v48, v49
    v_cvt_pk_bf16_f32 v97, v50, v51
    v_cvt_pk_bf16_f32 v98, v52, v53
    v_cvt_pk_bf16_f32 v99, v54, v55
    v_exp_f32 v58, v58
    v_exp_f32 v59, v59
    v_mfma_f32_32x32x16_bf16 v[64:79], v[112:115], v[96:99], v[64:79]
    ds_read_b128 v[112:115], v2 offset:51200
    v_xor_b32 v8, 32, v8
    ds_read_b64_tr_b16 a[92:93], v8 offset:0
    ds_read_b64_tr_b16 a[94:95], v8 offset:2048
    ds_read_b64_tr_b16 a[108:109], v8 offset:32768
    ds_read_b64_tr_b16 a[110:111], v8 offset:34816
    v_exp_f32 v60, v60
    v_exp_f32 v61, v61
    v_exp_f32 v62, v62
    v_exp_f32 v63, v63
    v_cvt_pk_bf16_f32 v100, v56, v57
    v_cvt_pk_bf16_f32 v101, v58, v59
    v_cvt_pk_bf16_f32 v102, v60, v61
    v_cvt_pk_bf16_f32 v103, v62, v63
    s_waitcnt lgkmcnt(12)
    v_mfma_f32_16x16x32_bf16 v[120:123], a[116:119], a[84:87], v[120:123]
    v_mfma_f32_16x16x32_bf16 v[124:127], a[116:119], a[100:103], v[124:127]
    s_waitcnt lgkmcnt(10)
    v_mfma_f32_32x32x16_bf16 v[48:63], v[104:107], v[16:19], v[80:95]
    v_exp_f32 v32, v32
    v_exp_f32 v33, v33
    v_exp_f32 v34, v34
    v_exp_f32 v35, v35
    v_mfma_f32_32x32x16_bf16 v[48:63], v[108:111], v[20:23], v[48:63]
    ds_read_b128 v[104:107], v2 offset:57344
    ds_read_b128 v[108:111], v2 offset:58368
    v_exp_f32 v36, v36
    v_exp_f32 v37, v37
    v_exp_f32 v38, v38
    v_exp_f32 v39, v39
    v_smfmac_f32_16x16x64_bf16 v[24:27], v[28:31], v[96:103], v15
    s_waitcnt lgkmcnt(6)
    v_exp_f32 v40, v40
    v_exp_f32 v41, v41
    v_mfma_f32_32x32x16_bf16 v[64:79], v[116:119], v[100:103], v[64:79]
    s_setprio 2
    ds_read_b128 v[116:119], v2 offset:52224
    v_mfma_f32_16x16x32_bf16 v[120:123], a[120:123], a[88:91], v[120:123]
    v_mfma_f32_16x16x32_bf16 v[124:127], a[120:123], a[104:107], v[124:127]
    v_cvt_pk_bf16_f32 v96, v32, v33
    v_cvt_pk_bf16_f32 v97, v34, v35
    v_cvt_pk_bf16_f32 v98, v36, v37
    v_cvt_pk_bf16_f32 v99, v38, v39
    v_exp_f32 v42, v42
    v_exp_f32 v43, v43
    v_mfma_f32_32x32x16_bf16 v[64:79], v[112:115], v[96:99], v[64:79]
    ds_read_b128 v[112:115], v2 offset:55296
    v_exp_f32 v44, v44
    v_exp_f32 v45, v45
    v_exp_f32 v46, v46
    v_exp_f32 v47, v47
    v_cvt_pk_bf16_f32 v100, v40, v41
    v_cvt_pk_bf16_f32 v101, v42, v43
    v_cvt_pk_bf16_f32 v102, v44, v45
    v_cvt_pk_bf16_f32 v103, v46, v47
    s_waitcnt lgkmcnt(4)
    v_mfma_f32_16x16x32_bf16 v[120:123], a[124:127], a[92:95], v[120:123]
    v_mfma_f32_16x16x32_bf16 v[124:127], a[124:127], a[108:111], v[124:127]
    s_waitcnt lgkmcnt(2)
    v_mfma_f32_32x32x16_bf16 v[32:47], v[104:107], v[16:19], v[80:95]
    v_exp_f32 v48, v48
    v_exp_f32 v49, v49
    v_exp_f32 v50, v50
    v_exp_f32 v51, v51
    v_mfma_f32_32x32x16_bf16 v[32:47], v[108:111], v[20:23], v[32:47]
    ds_read_b128 v[104:107], v2 offset:61440
    ds_read_b128 v[108:111], v2 offset:62464
    v_exp_f32 v52, v52
    v_exp_f32 v53, v53
    v_exp_f32 v54, v54
    v_exp_f32 v55, v55
    v_smfmac_f32_16x16x64_bf16 v[24:27], v[28:31], v[96:103], v15
    s_setprio 1
    s_waitcnt lgkmcnt(2)
    v_exp_f32 v56, v56
    v_exp_f32 v57, v57
    v_mfma_f32_32x32x16_bf16 v[64:79], v[116:119], v[100:103], v[64:79]
    ds_read_b128 v[116:119], v2 offset:56320
    ds_write_b32 v10, v120
    ds_write_b32 v10, v124 offset:256
    v_cvt_pk_bf16_f32 v96, v48, v49
    v_cvt_pk_bf16_f32 v97, v50, v51
    v_cvt_pk_bf16_f32 v98, v52, v53
    v_cvt_pk_bf16_f32 v99, v54, v55
    v_exp_f32 v58, v58
    v_exp_f32 v59, v59
    v_mfma_f32_32x32x16_bf16 v[64:79], v[112:115], v[96:99], v[64:79]
    s_setprio 0
    ds_read_b128 v[112:115], v2 offset:59392
    v_exp_f32 v60, v60
    v_exp_f32 v61, v61
    v_exp_f32 v62, v62
    v_exp_f32 v63, v63
    v_cvt_pk_bf16_f32 v100, v56, v57
    v_cvt_pk_bf16_f32 v101, v58, v59
    v_cvt_pk_bf16_f32 v102, v60, v61
    v_cvt_pk_bf16_f32 v103, v62, v63
    s_waitcnt lgkmcnt(4)
    v_mfma_f32_32x32x16_bf16 v[48:63], v[104:107], v[16:19], v[80:95]
    v_exp_f32 v32, v32
    v_exp_f32 v33, v33
    v_exp_f32 v34, v34
    v_exp_f32 v35, v35
    v_mfma_f32_32x32x16_bf16 v[48:63], v[108:111], v[20:23], v[48:63]
    s_waitcnt lgkmcnt(1)
    s_waitcnt vmcnt(4)
    s_barrier
    s_setprio 3
    ds_read_b128 v[104:107], v2 offset:0
    ds_read_b128 v[108:111], v2 offset:1024
    ds_read_b32 v120, v11 offset:0
    ds_read_b32 v121, v11 offset:4096
    ds_read_b32 v122, v11 offset:8192
    ds_read_b32 v123, v11 offset:12288
    ds_read_b32 v124, v11 offset:16384
    ds_read_b32 v125, v11 offset:20480
    ds_read_b32 v126, v11 offset:24576
    ds_read_b32 v127, v11 offset:28672
    v_exp_f32 v36, v36
    v_exp_f32 v37, v37
    v_exp_f32 v38, v38
    v_exp_f32 v39, v39
    v_smfmac_f32_16x16x64_bf16 v[24:27], v[28:31], v[96:103], v15
    s_waitcnt lgkmcnt(10)
    v_exp_f32 v40, v40
    v_exp_f32 v41, v41
    v_mfma_f32_32x32x16_bf16 v[64:79], v[116:119], v[100:103], v[64:79]
    ds_read_b128 v[116:119], v2 offset:60416
    s_add_u32 m0, s33, 32768
    s_cmp_ge_u32 s22, 10
    s_cselect_b32 s34, 0, 32768
    s_add_u32 s34, s34, s30
    s_add_u32 s34, s34, 294912
    buffer_load_dwordx4 v2, s[12:15], s34 offen offset:0 sc1 lds
    buffer_load_dwordx4 v2, s[12:15], s34 offen offset:1024 sc1 lds
    v_cvt_pk_bf16_f32 v96, v32, v33
    v_cvt_pk_bf16_f32 v97, v34, v35
    v_cvt_pk_bf16_f32 v98, v36, v37
    v_cvt_pk_bf16_f32 v99, v38, v39
    v_exp_f32 v42, v42
    v_exp_f32 v43, v43
    v_mfma_f32_32x32x16_bf16 v[64:79], v[112:115], v[96:99], v[64:79]
    ds_read_b128 v[112:115], v2 offset:63488
    s_add_u32 s58, s46, 0
    buffer_load_dwordx4 a[0:3], v2, s[12:15], s58 offen offset:0 sc1
    v_exp_f32 v44, v44
    v_exp_f32 v45, v45
    v_exp_f32 v46, v46
    v_exp_f32 v47, v47
    v_cvt_pk_bf16_f32 v100, v40, v41
    v_cvt_pk_bf16_f32 v101, v42, v43
    v_cvt_pk_bf16_f32 v102, v44, v45
    v_cvt_pk_bf16_f32 v103, v46, v47
    s_waitcnt lgkmcnt(2)
    v_add_f32 v120, v120, v124
    v_add_f32 v121, v121, v125
    v_add_f32 v122, v122, v126
    v_add_f32 v123, v123, v127
    v_add_f32 v120, v120, v122
    v_add_f32 v121, v121, v123
    v_add_f32 v120, v120, v121
    buffer_store_dword v120, v1, s[12:15], s48 offen sc1
    v_mfma_f32_32x32x16_bf16 v[32:47], v[104:107], v[16:19], v[80:95]
    v_exp_f32 v48, v48
    v_exp_f32 v49, v49
    v_exp_f32 v50, v50
    v_exp_f32 v51, v51
    v_mfma_f32_32x32x16_bf16 v[32:47], v[108:111], v[20:23], v[32:47]
    ds_read_b128 v[104:107], v2 offset:4096
    ds_read_b128 v[108:111], v2 offset:5120
    v_exp_f32 v52, v52
    v_exp_f32 v53, v53
    v_exp_f32 v54, v54
    v_exp_f32 v55, v55
    v_smfmac_f32_16x16x64_bf16 v[24:27], v[28:31], v[96:103], v15
    s_waitcnt lgkmcnt(2)
    v_exp_f32 v56, v56
    v_exp_f32 v57, v57
    v_mfma_f32_32x32x16_bf16 v[64:79], v[116:119], v[100:103], v[64:79]
    ds_read_b128 v[116:119], v2 offset:64512
    v_cvt_pk_bf16_f32 v96, v48, v49
    v_cvt_pk_bf16_f32 v97, v50, v51
    v_cvt_pk_bf16_f32 v98, v52, v53
    v_cvt_pk_bf16_f32 v99, v54, v55
    v_exp_f32 v58, v58
    v_exp_f32 v59, v59
    v_mfma_f32_32x32x16_bf16 v[64:79], v[112:115], v[96:99], v[64:79]
    ds_read_b128 v[112:115], v2 offset:2048
    buffer_load_dwordx4 a[4:7], v2, s[12:15], s58 offen offset:1024 sc1
    v_exp_f32 v60, v60
    v_exp_f32 v61, v61
    v_exp_f32 v62, v62
    v_exp_f32 v63, v63
    v_cvt_pk_bf16_f32 v100, v56, v57
    v_cvt_pk_bf16_f32 v101, v58, v59
    v_cvt_pk_bf16_f32 v102, v60, v61
    v_cvt_pk_bf16_f32 v103, v62, v63
    s_waitcnt lgkmcnt(2)
    v_mfma_f32_32x32x16_bf16 v[48:63], v[104:107], v[16:19], v[80:95]
    v_exp_f32 v32, v32
    v_exp_f32 v33, v33
    v_exp_f32 v34, v34
    v_exp_f32 v35, v35
    v_mfma_f32_32x32x16_bf16 v[48:63], v[108:111], v[20:23], v[48:63]
    ds_read_b128 v[104:107], v2 offset:8192
    ds_read_b128 v[108:111], v2 offset:9216
    v_exp_f32 v36, v36
    v_exp_f32 v37, v37
    v_exp_f32 v38, v38
    v_exp_f32 v39, v39
    v_smfmac_f32_16x16x64_bf16 v[24:27], v[28:31], v[96:103], v15
    s_waitcnt lgkmcnt(2)
    v_exp_f32 v40, v40
    v_exp_f32 v41, v41
    v_mfma_f32_32x32x16_bf16 v[64:79], v[116:119], v[100:103], v[64:79]
    s_setprio 2
    ds_read_b128 v[116:119], v2 offset:3072
    v_cvt_pk_bf16_f32 v96, v32, v33
    v_cvt_pk_bf16_f32 v97, v34, v35
    v_cvt_pk_bf16_f32 v98, v36, v37
    v_cvt_pk_bf16_f32 v99, v38, v39
    v_exp_f32 v42, v42
    v_exp_f32 v43, v43
    v_mfma_f32_32x32x16_bf16 v[64:79], v[112:115], v[96:99], v[64:79]
    ds_read_b128 v[112:115], v2 offset:6144
    buffer_load_dwordx4 a[8:11], v2, s[12:15], s58 offen offset:2048 sc1
    v_exp_f32 v44, v44
    v_exp_f32 v45, v45
    v_exp_f32 v46, v46
    v_exp_f32 v47, v47
    v_cvt_pk_bf16_f32 v100, v40, v41
    v_cvt_pk_bf16_f32 v101, v42, v43
    v_cvt_pk_bf16_f32 v102, v44, v45
    v_cvt_pk_bf16_f32 v103, v46, v47
    s_waitcnt lgkmcnt(2)
    v_mfma_f32_32x32x16_bf16 v[32:47], v[104:107], v[16:19], v[80:95]
    v_exp_f32 v48, v48
    v_exp_f32 v49, v49
    v_exp_f32 v50, v50
    v_exp_f32 v51, v51
    v_mfma_f32_32x32x16_bf16 v[32:47], v[108:111], v[20:23], v[32:47]
    ds_read_b128 v[104:107], v2 offset:12288
    ds_read_b128 v[108:111], v2 offset:13312
    v_exp_f32 v52, v52
    v_exp_f32 v53, v53
    v_exp_f32 v54, v54
    v_exp_f32 v55, v55
    v_smfmac_f32_16x16x64_bf16 v[24:27], v[28:31], v[96:103], v15
    s_setprio 1
    s_waitcnt lgkmcnt(2)
    v_exp_f32 v56, v56
    v_exp_f32 v57, v57
    v_mfma_f32_32x32x16_bf16 v[64:79], v[116:119], v[100:103], v[64:79]
    ds_read_b128 v[116:119], v2 offset:7168
    v_cvt_pk_bf16_f32 v96, v48, v49
    v_cvt_pk_bf16_f32 v97, v50, v51
    v_cvt_pk_bf16_f32 v98, v52, v53
    v_cvt_pk_bf16_f32 v99, v54, v55
    v_exp_f32 v58, v58
    v_exp_f32 v59, v59
    v_mfma_f32_32x32x16_bf16 v[64:79], v[112:115], v[96:99], v[64:79]
    s_setprio 0
    ds_read_b128 v[112:115], v2 offset:10240
    buffer_load_dwordx4 a[12:15], v2, s[12:15], s58 offen offset:3072 sc1
    v_exp_f32 v60, v60
    v_exp_f32 v61, v61
    v_exp_f32 v62, v62
    v_exp_f32 v63, v63
    v_cvt_pk_bf16_f32 v100, v56, v57
    v_cvt_pk_bf16_f32 v101, v58, v59
    v_cvt_pk_bf16_f32 v102, v60, v61
    v_cvt_pk_bf16_f32 v103, v62, v63
    s_waitcnt lgkmcnt(2)
    v_mfma_f32_32x32x16_bf16 v[48:63], v[104:107], v[16:19], v[80:95]
    v_exp_f32 v32, v32
    v_exp_f32 v33, v33
    v_exp_f32 v34, v34
    v_exp_f32 v35, v35
    v_mfma_f32_32x32x16_bf16 v[48:63], v[108:111], v[20:23], v[48:63]
    s_waitcnt vmcnt(3)
    s_barrier
    buffer_store_dword v6, v3, s[12:15], s49 offen sc1
    s_setprio 3
    ds_read_b128 v[104:107], v2 offset:16384
    ds_read_b128 v[108:111], v2 offset:17408
    v_exp_f32 v36, v36
    v_exp_f32 v37, v37
    v_exp_f32 v38, v38
    v_exp_f32 v39, v39
    v_smfmac_f32_16x16x64_bf16 v[24:27], v[28:31], v[96:103], v15
    s_waitcnt lgkmcnt(2)
    v_exp_f32 v40, v40
    v_exp_f32 v41, v41
    v_mfma_f32_32x32x16_bf16 v[64:79], v[116:119], v[100:103], v[64:79]
    ds_read_b128 v[116:119], v2 offset:11264
    s_add_u32 m0, s33, 49152
    s_cmp_ge_u32 s22, 11
    s_cselect_b32 s34, 0, 32768
    s_add_u32 s34, s34, s30
    s_add_u32 s34, s34, 327680
    buffer_load_dwordx4 v2, s[12:15], s34 offen offset:0 sc1 lds
    buffer_load_dwordx4 v2, s[12:15], s34 offen offset:1024 sc1 lds
    v_cvt_pk_bf16_f32 v96, v32, v33
    v_cvt_pk_bf16_f32 v97, v34, v35
    v_cvt_pk_bf16_f32 v98, v36, v37
    v_cvt_pk_bf16_f32 v99, v38, v39
    v_exp_f32 v42, v42
    v_exp_f32 v43, v43
    v_mfma_f32_32x32x16_bf16 v[64:79], v[112:115], v[96:99], v[64:79]
    ds_read_b128 v[112:115], v2 offset:14336
    s_add_u32 s58, s46, 4096
    buffer_load_dwordx4 a[16:19], v2, s[12:15], s58 offen offset:0 sc1
    v_exp_f32 v44, v44
    v_exp_f32 v45, v45
    v_exp_f32 v46, v46
    v_exp_f32 v47, v47
    v_cvt_pk_bf16_f32 v100, v40, v41
    v_cvt_pk_bf16_f32 v101, v42, v43
    v_cvt_pk_bf16_f32 v102, v44, v45
    v_cvt_pk_bf16_f32 v103, v46, v47
    s_waitcnt lgkmcnt(2)
    v_mfma_f32_32x32x16_bf16 v[32:47], v[104:107], v[16:19], v[80:95]
    v_exp_f32 v48, v48
    v_exp_f32 v49, v49
    v_exp_f32 v50, v50
    v_exp_f32 v51, v51
    v_mfma_f32_32x32x16_bf16 v[32:47], v[108:111], v[20:23], v[32:47]
    ds_read_b128 v[104:107], v2 offset:20480
    ds_read_b128 v[108:111], v2 offset:21504
    v_exp_f32 v52, v52
    v_exp_f32 v53, v53
    v_exp_f32 v54, v54
    v_exp_f32 v55, v55
    v_smfmac_f32_16x16x64_bf16 v[24:27], v[28:31], v[96:103], v15
    s_waitcnt lgkmcnt(2)
    v_exp_f32 v56, v56
    v_exp_f32 v57, v57
    v_mfma_f32_32x32x16_bf16 v[64:79], v[116:119], v[100:103], v[64:79]
    ds_read_b128 v[116:119], v2 offset:15360
    v_cvt_pk_bf16_f32 v96, v48, v49
    v_cvt_pk_bf16_f32 v97, v50, v51
    v_cvt_pk_bf16_f32 v98, v52, v53
    v_cvt_pk_bf16_f32 v99, v54, v55
    v_exp_f32 v58, v58
    v_exp_f32 v59, v59
    v_mfma_f32_32x32x16_bf16 v[64:79], v[112:115], v[96:99], v[64:79]
    ds_read_b128 v[112:115], v2 offset:18432
    buffer_load_dwordx4 a[20:23], v2, s[12:15], s58 offen offset:1024 sc1
    v_exp_f32 v60, v60
    v_exp_f32 v61, v61
    v_exp_f32 v62, v62
    v_exp_f32 v63, v63
    v_cvt_pk_bf16_f32 v100, v56, v57
    v_cvt_pk_bf16_f32 v101, v58, v59
    v_cvt_pk_bf16_f32 v102, v60, v61
    v_cvt_pk_bf16_f32 v103, v62, v63
    s_waitcnt lgkmcnt(2)
    v_mfma_f32_32x32x16_bf16 v[48:63], v[104:107], v[16:19], v[80:95]
    v_exp_f32 v32, v32
    v_exp_f32 v33, v33
    v_exp_f32 v34, v34
    v_exp_f32 v35, v35
    v_mfma_f32_32x32x16_bf16 v[48:63], v[108:111], v[20:23], v[48:63]
    ds_read_b128 v[104:107], v2 offset:24576
    ds_read_b128 v[108:111], v2 offset:25600
    v_exp_f32 v36, v36
    v_exp_f32 v37, v37
    v_exp_f32 v38, v38
    v_exp_f32 v39, v39
    v_smfmac_f32_16x16x64_bf16 v[24:27], v[28:31], v[96:103], v15
    s_waitcnt lgkmcnt(2)
    v_exp_f32 v40, v40
    v_exp_f32 v41, v41
    v_mfma_f32_32x32x16_bf16 v[64:79], v[116:119], v[100:103], v[64:79]
    s_setprio 2
    ds_read_b128 v[116:119], v2 offset:19456
    v_cvt_pk_bf16_f32 v96, v32, v33
    v_cvt_pk_bf16_f32 v97, v34, v35
    v_cvt_pk_bf16_f32 v98, v36, v37
    v_cvt_pk_bf16_f32 v99, v38, v39
    v_exp_f32 v42, v42
    v_exp_f32 v43, v43
    v_mfma_f32_32x32x16_bf16 v[64:79], v[112:115], v[96:99], v[64:79]
    ds_read_b128 v[112:115], v2 offset:22528
    buffer_load_dwordx4 a[24:27], v2, s[12:15], s58 offen offset:2048 sc1
    v_exp_f32 v44, v44
    v_exp_f32 v45, v45
    v_exp_f32 v46, v46
    v_exp_f32 v47, v47
    v_cvt_pk_bf16_f32 v100, v40, v41
    v_cvt_pk_bf16_f32 v101, v42, v43
    v_cvt_pk_bf16_f32 v102, v44, v45
    v_cvt_pk_bf16_f32 v103, v46, v47
    s_waitcnt lgkmcnt(2)
    v_mfma_f32_32x32x16_bf16 v[32:47], v[104:107], v[16:19], v[80:95]
    v_exp_f32 v48, v48
    v_exp_f32 v49, v49
    v_exp_f32 v50, v50
    v_exp_f32 v51, v51
    v_mfma_f32_32x32x16_bf16 v[32:47], v[108:111], v[20:23], v[32:47]
    ds_read_b128 v[104:107], v2 offset:28672
    ds_read_b128 v[108:111], v2 offset:29696
    v_exp_f32 v52, v52
    v_exp_f32 v53, v53
    v_exp_f32 v54, v54
    v_exp_f32 v55, v55
    v_smfmac_f32_16x16x64_bf16 v[24:27], v[28:31], v[96:103], v15
    s_setprio 1
    s_waitcnt lgkmcnt(2)
    v_exp_f32 v56, v56
    v_exp_f32 v57, v57
    v_mfma_f32_32x32x16_bf16 v[64:79], v[116:119], v[100:103], v[64:79]
    ds_read_b128 v[116:119], v2 offset:23552
    v_cvt_pk_bf16_f32 v96, v48, v49
    v_cvt_pk_bf16_f32 v97, v50, v51
    v_cvt_pk_bf16_f32 v98, v52, v53
    v_cvt_pk_bf16_f32 v99, v54, v55
    v_exp_f32 v58, v58
    v_exp_f32 v59, v59
    v_mfma_f32_32x32x16_bf16 v[64:79], v[112:115], v[96:99], v[64:79]
    s_setprio 0
    ds_read_b128 v[112:115], v2 offset:26624
    buffer_load_dwordx4 a[28:31], v2, s[12:15], s58 offen offset:3072 sc1
    v_exp_f32 v60, v60
    v_exp_f32 v61, v61
    v_exp_f32 v62, v62
    v_exp_f32 v63, v63
    v_cvt_pk_bf16_f32 v100, v56, v57
    v_cvt_pk_bf16_f32 v101, v58, v59
    v_cvt_pk_bf16_f32 v102, v60, v61
    v_cvt_pk_bf16_f32 v103, v62, v63
    s_waitcnt lgkmcnt(2)
    v_mfma_f32_32x32x16_bf16 v[48:63], v[104:107], v[16:19], v[80:95]
    v_exp_f32 v32, v32
    v_exp_f32 v33, v33
    v_exp_f32 v34, v34
    v_exp_f32 v35, v35
    v_mfma_f32_32x32x16_bf16 v[48:63], v[108:111], v[20:23], v[48:63]
    s_barrier
    s_cmp_lg_u32 s20, 3
    s_cbranch_scc1 L_28
    buffer_load_dword v7, v1, s[12:15], s50 offen sc1
L_28:
    s_setprio 3
    ds_read_b128 v[104:107], v2 offset:32768
    ds_read_b128 v[108:111], v2 offset:33792
    v_exp_f32 v36, v36
    v_exp_f32 v37, v37
    v_exp_f32 v38, v38
    v_exp_f32 v39, v39
    v_smfmac_f32_16x16x64_bf16 v[24:27], v[28:31], v[96:103], v15
    s_waitcnt lgkmcnt(2)
    v_exp_f32 v40, v40
    v_exp_f32 v41, v41
    v_mfma_f32_32x32x16_bf16 v[64:79], v[116:119], v[100:103], v[64:79]
    ds_read_b128 v[116:119], v2 offset:27648
    s_add_u32 m0, s33, 0
    s_cmp_ge_u32 s22, 12
    s_cselect_b32 s34, 0, 32768
    s_add_u32 s34, s34, s30
    s_add_u32 s34, s34, 360448
    buffer_load_dwordx4 v2, s[12:15], s34 offen offset:0 sc1 lds
    buffer_load_dwordx4 v2, s[12:15], s34 offen offset:1024 sc1 lds
    v_cvt_pk_bf16_f32 v96, v32, v33
    v_cvt_pk_bf16_f32 v97, v34, v35
    v_cvt_pk_bf16_f32 v98, v36, v37
    v_cvt_pk_bf16_f32 v99, v38, v39
    v_exp_f32 v42, v42
    v_exp_f32 v43, v43
    v_mfma_f32_32x32x16_bf16 v[64:79], v[112:115], v[96:99], v[64:79]
    ds_read_b128 v[112:115], v2 offset:30720
    s_add_u32 s58, s46, 8192
    buffer_load_dwordx4 a[32:35], v2, s[12:15], s58 offen offset:0 sc1
    v_exp_f32 v44, v44
    v_exp_f32 v45, v45
    v_exp_f32 v46, v46
    v_exp_f32 v47, v47
    v_cvt_pk_bf16_f32 v100, v40, v41
    v_cvt_pk_bf16_f32 v101, v42, v43
    v_cvt_pk_bf16_f32 v102, v44, v45
    v_cvt_pk_bf16_f32 v103, v46, v47
    s_waitcnt lgkmcnt(2)
    v_mfma_f32_32x32x16_bf16 v[32:47], v[104:107], v[16:19], v[80:95]
    v_exp_f32 v48, v48
    v_exp_f32 v49, v49
    v_exp_f32 v50, v50
    v_exp_f32 v51, v51
    v_mfma_f32_32x32x16_bf16 v[32:47], v[108:111], v[20:23], v[32:47]
    ds_read_b128 v[104:107], v2 offset:36864
    ds_read_b128 v[108:111], v2 offset:37888
    v_exp_f32 v52, v52
    v_exp_f32 v53, v53
    v_exp_f32 v54, v54
    v_exp_f32 v55, v55
    v_smfmac_f32_16x16x64_bf16 v[24:27], v[28:31], v[96:103], v15
    s_waitcnt lgkmcnt(2)
    v_exp_f32 v56, v56
    v_exp_f32 v57, v57
    v_mfma_f32_32x32x16_bf16 v[64:79], v[116:119], v[100:103], v[64:79]
    ds_read_b128 v[116:119], v2 offset:31744
    v_cvt_pk_bf16_f32 v96, v48, v49
    v_cvt_pk_bf16_f32 v97, v50, v51
    v_cvt_pk_bf16_f32 v98, v52, v53
    v_cvt_pk_bf16_f32 v99, v54, v55
    v_exp_f32 v58, v58
    v_exp_f32 v59, v59
    v_mfma_f32_32x32x16_bf16 v[64:79], v[112:115], v[96:99], v[64:79]
    ds_read_b128 v[112:115], v2 offset:34816
    buffer_load_dwordx4 a[36:39], v2, s[12:15], s58 offen offset:1024 sc1
    v_exp_f32 v60, v60
    v_exp_f32 v61, v61
    v_exp_f32 v62, v62
    v_exp_f32 v63, v63
    v_cvt_pk_bf16_f32 v100, v56, v57
    v_cvt_pk_bf16_f32 v101, v58, v59
    v_cvt_pk_bf16_f32 v102, v60, v61
    v_cvt_pk_bf16_f32 v103, v62, v63
    s_waitcnt lgkmcnt(2)
    v_mfma_f32_32x32x16_bf16 v[48:63], v[104:107], v[16:19], v[80:95]
    v_exp_f32 v32, v32
    v_exp_f32 v33, v33
    v_exp_f32 v34, v34
    v_exp_f32 v35, v35
    v_mfma_f32_32x32x16_bf16 v[48:63], v[108:111], v[20:23], v[48:63]
    ds_read_b128 v[104:107], v2 offset:40960
    ds_read_b128 v[108:111], v2 offset:41984
    v_exp_f32 v36, v36
    v_exp_f32 v37, v37
    v_exp_f32 v38, v38
    v_exp_f32 v39, v39
    v_smfmac_f32_16x16x64_bf16 v[24:27], v[28:31], v[96:103], v15
    s_waitcnt lgkmcnt(2)
    v_exp_f32 v40, v40
    v_exp_f32 v41, v41
    v_mfma_f32_32x32x16_bf16 v[64:79], v[116:119], v[100:103], v[64:79]
    s_setprio 2
    ds_read_b128 v[116:119], v2 offset:35840
    v_cvt_pk_bf16_f32 v96, v32, v33
    v_cvt_pk_bf16_f32 v97, v34, v35
    v_cvt_pk_bf16_f32 v98, v36, v37
    v_cvt_pk_bf16_f32 v99, v38, v39
    v_exp_f32 v42, v42
    v_exp_f32 v43, v43
    v_mfma_f32_32x32x16_bf16 v[64:79], v[112:115], v[96:99], v[64:79]
    ds_read_b128 v[112:115], v2 offset:38912
    buffer_load_dwordx4 a[40:43], v2, s[12:15], s58 offen offset:2048 sc1
    v_exp_f32 v44, v44
    v_exp_f32 v45, v45
    v_exp_f32 v46, v46
    v_exp_f32 v47, v47
    v_cvt_pk_bf16_f32 v100, v40, v41
    v_cvt_pk_bf16_f32 v101, v42, v43
    v_cvt_pk_bf16_f32 v102, v44, v45
    v_cvt_pk_bf16_f32 v103, v46, v47
    s_waitcnt lgkmcnt(2)
    v_mfma_f32_32x32x16_bf16 v[32:47], v[104:107], v[16:19], v[80:95]
    v_exp_f32 v48, v48
    v_exp_f32 v49, v49
    v_exp_f32 v50, v50
    v_exp_f32 v51, v51
    v_mfma_f32_32x32x16_bf16 v[32:47], v[108:111], v[20:23], v[32:47]
    ds_read_b128 v[104:107], v2 offset:45056
    ds_read_b128 v[108:111], v2 offset:46080
    v_exp_f32 v52, v52
    v_exp_f32 v53, v53
    v_exp_f32 v54, v54
    v_exp_f32 v55, v55
    v_smfmac_f32_16x16x64_bf16 v[24:27], v[28:31], v[96:103], v15
    s_setprio 1
    s_waitcnt lgkmcnt(2)
    v_exp_f32 v56, v56
    v_exp_f32 v57, v57
    v_mfma_f32_32x32x16_bf16 v[64:79], v[116:119], v[100:103], v[64:79]
    ds_read_b128 v[116:119], v2 offset:39936
    v_cvt_pk_bf16_f32 v96, v48, v49
    v_cvt_pk_bf16_f32 v97, v50, v51
    v_cvt_pk_bf16_f32 v98, v52, v53
    v_cvt_pk_bf16_f32 v99, v54, v55
    v_exp_f32 v58, v58
    v_exp_f32 v59, v59
    v_mfma_f32_32x32x16_bf16 v[64:79], v[112:115], v[96:99], v[64:79]
    s_setprio 0
    ds_read_b128 v[112:115], v2 offset:43008
    buffer_load_dwordx4 a[44:47], v2, s[12:15], s58 offen offset:3072 sc1
    v_exp_f32 v60, v60
    v_exp_f32 v61, v61
    v_exp_f32 v62, v62
    v_exp_f32 v63, v63
    v_cvt_pk_bf16_f32 v100, v56, v57
    v_cvt_pk_bf16_f32 v101, v58, v59
    v_cvt_pk_bf16_f32 v102, v60, v61
    v_cvt_pk_bf16_f32 v103, v62, v63
    s_waitcnt lgkmcnt(2)
    v_mfma_f32_32x32x16_bf16 v[48:63], v[104:107], v[16:19], v[80:95]
    v_exp_f32 v32, v32
    v_exp_f32 v33, v33
    v_exp_f32 v34, v34
    v_exp_f32 v35, v35
    v_mfma_f32_32x32x16_bf16 v[48:63], v[108:111], v[20:23], v[48:63]
    s_waitcnt vmcnt(10)
    s_barrier
    s_cmp_lg_u32 s20, 3
    s_cbranch_scc1 L_29
    s_waitcnt vmcnt(6)
    s_mov_b32 s3, 300000
L_spin_30:
    v_cmp_ne_u32 vcc, s23, v7
    s_nop 1
    s_and_b32 vcc_lo, vcc_lo, 15
    s_cmp_eq_u32 vcc_lo, 0
    s_cbranch_scc1 L_ok_31
    buffer_load_dword v7, v1, s[12:15], s50 offen sc1
    s_waitcnt vmcnt(0)
    s_sub_u32 s3, s3, 1
    s_cmp_lg_u32 s3, 0
    s_cbranch_scc1 L_spin_30
    s_endpgm
L_ok_31:
    v_lshrrev_b32 v5, 4, v0
    v_and_b32 v7, 15, v0
    v_lshlrev_b32 v7, 2, v7
    v_lshl_add_u32 v5, v5, 9, v7
    buffer_load_dword v120, v5, s[12:15], s51 offen sc1
    buffer_load_dword v121, v5, s[12:15], s51 offen offset:256 sc1
L_29:
    s_setprio 3
    ds_read_b128 v[104:107], v2 offset:49152
    ds_read_b128 v[108:111], v2 offset:50176
    v_exp_f32 v36, v36
    v_exp_f32 v37, v37
    v_exp_f32 v38, v38
    v_exp_f32 v39, v39
    v_smfmac_f32_16x16x64_bf16 v[24:27], v[28:31], v[96:103], v15
    s_waitcnt lgkmcnt(2)
    v_exp_f32 v40, v40
    v_exp_f32 v41, v41
    v_mfma_f32_32x32x16_bf16 v[64:79], v[116:119], v[100:103], v[64:79]
    ds_read_b128 v[116:119], v2 offset:44032
    s_add_u32 m0, s33, 16384
    s_cmp_ge_u32 s22, 13
    s_cselect_b32 s34, 0, 32768
    s_add_u32 s34, s34, s30
    s_add_u32 s34, s34, 393216
    buffer_load_dwordx4 v2, s[12:15], s34 offen offset:0 sc1 lds
    buffer_load_dwordx4 v2, s[12:15], s34 offen offset:1024 sc1 lds
    v_cvt_pk_bf16_f32 v96, v32, v33
    v_cvt_pk_bf16_f32 v97, v34, v35
    v_cvt_pk_bf16_f32 v98, v36, v37
    v_cvt_pk_bf16_f32 v99, v38, v39
    v_exp_f32 v42, v42
    v_exp_f32 v43, v43
    v_mfma_f32_32x32x16_bf16 v[64:79], v[112:115], v[96:99], v[64:79]
    ds_read_b128 v[112:115], v2 offset:47104
    s_add_u32 s58, s46, 12288
    buffer_load_dwordx4 a[48:51], v2, s[12:15], s58 offen offset:0 sc1
    ds_read_b64_tr_b16 a[96:97], v12 offset:0
    ds_read_b64_tr_b16 a[98:99], v12 offset:8192
    v_exp_f32 v44, v44
    v_exp_f32 v45, v45
    v_exp_f32 v46, v46
    v_exp_f32 v47, v47
    v_cvt_pk_bf16_f32 v100, v40, v41
    v_cvt_pk_bf16_f32 v101, v42, v43
    v_cvt_pk_bf16_f32 v102, v44, v45
    v_cvt_pk_bf16_f32 v103, v46, v47
    s_waitcnt lgkmcnt(4)
    v_mfma_f32_32x32x16_bf16 v[32:47], v[104:107], v[16:19], v[80:95]
    v_exp_f32 v48, v48
    v_exp_f32 v49, v49
    v_exp_f32 v50, v50
    v_exp_f32 v51, v51
    v_mfma_f32_32x32x16_bf16 v[32:47], v[108:111], v[20:23], v[32:47]
    ds_read_b128 v[104:107], v2 offset:53248
    ds_read_b128 v[108:111], v2 offset:54272
    v_exp_f32 v52, v52
    v_exp_f32 v53, v53
    v_exp_f32 v54, v54
    v_exp_f32 v55, v55
    v_smfmac_f32_16x16x64_bf16 v[24:27], v[28:31], v[96:103], v15
    s_waitcnt lgkmcnt(4)
    v_exp_f32 v56, v56
    v_exp_f32 v57, v57
    v_mfma_f32_32x32x16_bf16 v[64:79], v[116:119], v[100:103], v[64:79]
    ds_read_b128 v[116:119], v2 offset:48128
    v_cvt_pk_bf16_f32 v96, v48, v49
    v_cvt_pk_bf16_f32 v97, v50, v51
    v_cvt_pk_bf16_f32 v98, v52, v53
    v_cvt_pk_bf16_f32 v99, v54, v55
    v_exp_f32 v58, v58
    v_exp_f32 v59, v59
    v_mfma_f32_32x32x16_bf16 v[64:79], v[112:115], v[96:99], v[64:79]
    ds_read_b128 v[112:115], v2 offset:51200
    buffer_load_dwordx4 a[52:55], v2, s[12:15], s58 offen offset:1024 sc1
    ds_read_b64_tr_b16 a[100:101], v12 offset:64
    ds_read_b64_tr_b16 a[102:103], v12 offset:8256
    v_exp_f32 v60, v60
    v_exp_f32 v61, v61
    v_exp_f32 v62, v62
    v_exp_f32 v63, v63
    v_cvt_pk_bf16_f32 v100, v56, v57
    v_cvt_pk_bf16_f32 v101, v58, v59
    v_cvt_pk_bf16_f32 v102, v60, v61
    v_cvt_pk_bf16_f32 v103, v62, v63
    s_waitcnt lgkmcnt(4)
    v_mfma_f32_32x32x16_bf16 v[48:63], v[104:107], v[16:19], v[80:95]
    v_exp_f32 v32, v32
    v_exp_f32 v33, v33
    v_exp_f32 v34, v34
    v_exp_f32 v35, v35
    v_mfma_f32_32x32x16_bf16 v[48:63], v[108:111], v[20:23], v[48:63]
    ds_read_b128 v[104:107], v2 offset:57344
    ds_read_b128 v[108:111], v2 offset:58368
    v_exp_f32 v36, v36
    v_exp_f32 v37, v37
    v_exp_f32 v38, v38
    v_exp_f32 v39, v39
    v_smfmac_f32_16x16x64_bf16 v[24:27], v[28:31], v[96:103], v15
    s_waitcnt lgkmcnt(4)
    v_exp_f32 v40, v40
    v_exp_f32 v41, v41
    v_mfma_f32_32x32x16_bf16 v[64:79], v[116:119], v[100:103], v[64:79]
    s_setprio 2
    ds_read_b128 v[116:119], v2 offset:52224
    v_cvt_pk_bf16_f32 v96, v32, v33
    v_cvt_pk_bf16_f32 v97, v34, v35
    v_cvt_pk_bf16_f32 v98, v36, v37
    v_cvt_pk_bf16_f32 v99, v38, v39
    v_exp_f32 v42, v42
    v_exp_f32 v43, v43
    v_mfma_f32_32x32x16_bf16 v[64:79], v[112:115], v[96:99], v[64:79]
    ds_read_b128 v[112:115], v2 offset:55296
    buffer_load_dwordx4 a[56:59], v2, s[12:15], s58 offen offset:2048 sc1
    ds_read_b64_tr_b16 a[104:105], v12 offset:128
    ds_read_b64_tr_b16 a[106:107], v12 offset:8320
    v_exp_f32 v44, v44
    v_exp_f32 v45, v45
    v_exp_f32 v46, v46
    v_exp_f32 v47, v47
    v_cvt_pk_bf16_f32 v100, v40, v41
    v_cvt_pk_bf16_f32 v101, v42, v43
    v_cvt_pk_bf16_f32 v102, v44, v45
    v_cvt_pk_bf16_f32 v103, v46, v47
    s_waitcnt lgkmcnt(4)
    v_mfma_f32_32x32x16_bf16 v[32:47], v[104:107], v[16:19], v[80:95]
    v_exp_f32 v48, v48
    v_exp_f32 v49, v49
    v_exp_f32 v50, v50
    v_exp_f32 v51, v51
    v_mfma_f32_32x32x16_bf16 v[32:47], v[108:111], v[20:23], v[32:47]
    ds_read_b128 v[104:107], v2 offset:61440
    ds_read_b128 v[108:111], v2 offset:62464
    s_cmp_lg_u32 s20, 3
    s_cbranch_scc1 L_32
    s_waitcnt vmcnt(5)
    v_mov_b32 v122, v120
    v_mov_b32 v123, v121
    s_nop 0
    v_permlane16_swap_b32 v120, v122
    v_permlane16_swap_b32 v121, v123
    v_add_f32 v120, v120, v122
    v_add_f32 v121, v121, v123
    v_mov_b32 v122, v120
    v_mov_b32 v123, v121
    s_nop 0
    v_permlane32_swap_b32 v120, v122
    v_permlane32_swap_b32 v121, v123
    v_add_f32 v120, v120, v122
    v_add_f32 v121, v121, v123
    v_cvt_pk_bf16_f32 v120, v120, v121
    v_and_b32 v121, 0xffff0000, v120
    v_lshlrev_b32 v120, 16, v120
    v_mul_f32 v122, 0xbfb8aa3b, v120
    v_exp_f32 v122, v122
    s_nop 0
    v_add_f32 v122, 1.0, v122
    v_rcp_f32 v122, v122
    v_and_b32 v7, 31, v0
    v_mul_f32 v120, v120, v122
    v_cvt_pk_bf16_f32 v120, v120, v120
    v_and_b32 v120, 0xffff0000, v120
    v_mul_f32 v120, v120, v121
    v_cvt_pk_bf16_f32 v120, v120, v120
    v_cmp_gt_u32 vcc, 16, v7
    v_lshlrev_b32 v7, 1, v7
    v_add_u32 v7, 98304, v7
    v_cndmask_b32 v120, 0, v120, vcc
    ds_write_b16 v7, v120
    s_waitcnt lgkmcnt(0)
L_32:
    v_exp_f32 v52, v52
    v_exp_f32 v53, v53
    v_exp_f32 v54, v54
    v_exp_f32 v55, v55
    v_smfmac_f32_16x16x64_bf16 v[24:27], v[28:31], v[96:103], v15
    s_setprio 1
    s_waitcnt lgkmcnt(4)
    v_exp_f32 v56, v56
    v_exp_f32 v57, v57
    v_mfma_f32_32x32x16_bf16 v[64:79], v[116:119], v[100:103], v[64:79]
    ds_read_b128 v[116:119], v2 offset:56320
    v_cvt_pk_bf16_f32 v96, v48, v49
    v_cvt_pk_bf16_f32 v97, v50, v51
    v_cvt_pk_bf16_f32 v98, v52, v53
    v_cvt_pk_bf16_f32 v99, v54, v55
    v_exp_f32 v58, v58
    v_exp_f32 v59, v59
    v_mfma_f32_32x32x16_bf16 v[64:79], v[112:115], v[96:99], v[64:79]
    s_setprio 0
    ds_read_b128 v[112:115], v2 offset:59392
    buffer_load_dwordx4 a[60:63], v2, s[12:15], s58 offen offset:3072 sc1
    ds_read_b64_tr_b16 a[108:109], v12 offset:192
    ds_read_b64_tr_b16 a[110:111], v12 offset:8384
    v_exp_f32 v60, v60
    v_exp_f32 v61, v61
    v_exp_f32 v62, v62
    v_exp_f32 v63, v63
    v_cvt_pk_bf16_f32 v100, v56, v57
    v_cvt_pk_bf16_f32 v101, v58, v59
    v_cvt_pk_bf16_f32 v102, v60, v61
    v_cvt_pk_bf16_f32 v103, v62, v63
    s_waitcnt lgkmcnt(4)
    v_mfma_f32_32x32x16_bf16 v[48:63], v[104:107], v[16:19], v[80:95]
    v_exp_f32 v32, v32
    v_exp_f32 v33, v33
    v_exp_f32 v34, v34
    v_exp_f32 v35, v35
    v_mfma_f32_32x32x16_bf16 v[48:63], v[108:111], v[20:23], v[48:63]
    s_waitcnt vmcnt(10)
    s_barrier
    s_setprio 3
    ds_read_b128 v[104:107], v2 offset:0
    ds_read_b128 v[108:111], v2 offset:1024
    v_xor_b32 v13, 32, v14
    ds_read_b128 a[112:115], v14
    ds_read_b128 a[116:119], v13
    v_exp_f32 v36, v36
    v_exp_f32 v37, v37
    v_exp_f32 v38, v38
    v_exp_f32 v39, v39
    v_smfmac_f32_16x16x64_bf16 v[24:27], v[28:31], v[96:103], v15
    s_waitcnt lgkmcnt(6)
    v_exp_f32 v40, v40
    v_exp_f32 v41, v41
    v_mfma_f32_32x32x16_bf16 v[64:79], v[116:119], v[100:103], v[64:79]
    ds_read_b128 v[116:119], v2 offset:60416
    s_add_u32 m0, s33, 32768
    s_cmp_ge_u32 s22, 14
    s_cselect_b32 s34, 0, 32768
    s_add_u32 s34, s34, s30
    s_add_u32 s34, s34, 425984
    buffer_load_dwordx4 v2, s[12:15], s34 offen offset:0 sc1 lds
    buffer_load_dwordx4 v2, s[12:15], s34 offen offset:1024 sc1 lds
    v_cvt_pk_bf16_f32 v96, v32, v33
    v_cvt_pk_bf16_f32 v97, v34, v35
    v_cvt_pk_bf16_f32 v98, v36, v37
    v_cvt_pk_bf16_f32 v99, v38, v39
    v_exp_f32 v42, v42
    v_exp_f32 v43, v43
    v_mfma_f32_32x32x16_bf16 v[64:79], v[112:115], v[96:99], v[64:79]
    ds_read_b128 v[112:115], v2 offset:63488
    v_exp_f32 v44, v44
    v_exp_f32 v45, v45
    v_exp_f32 v46, v46
    v_exp_f32 v47, v47
    v_cvt_pk_bf16_f32 v100, v40, v41
    v_cvt_pk_bf16_f32 v101, v42, v43
    v_cvt_pk_bf16_f32 v102, v44, v45
    v_cvt_pk_bf16_f32 v103, v46, v47
    s_waitcnt lgkmcnt(4)
    v_mfma_f32_32x32x16_bf16 v[32:47], v[104:107], v[16:19], v[80:95]
    v_exp_f32 v48, v48
    v_exp_f32 v49, v49
    v_exp_f32 v50, v50
    v_exp_f32 v51, v51
    v_mfma_f32_32x32x16_bf16 v[32:47], v[108:111], v[20:23], v[32:47]
    ds_read_b128 v[104:107], v2 offset:4096
    ds_read_b128 v[108:111], v2 offset:5120
    s_waitcnt lgkmcnt(4)
    v_mfma_f32_32x32x16_bf16 a[80:95], a[112:115], a[96:99], 0
    v_exp_f32 v52, v52
    v_exp_f32 v53, v53
    v_exp_f32 v54, v54
    v_exp_f32 v55, v55
    v_smfmac_f32_16x16x64_bf16 v[24:27], v[28:31], v[96:103], v15
    s_waitcnt lgkmcnt(2)
    v_exp_f32 v56, v56
    v_exp_f32 v57, v57
    v_mfma_f32_32x32x16_bf16 v[64:79], v[116:119], v[100:103], v[64:79]
    ds_read_b128 v[116:119], v2 offset:64512
    v_cvt_pk_bf16_f32 v96, v48, v49
    v_cvt_pk_bf16_f32 v97, v50, v51
    v_cvt_pk_bf16_f32 v98, v52, v53
    v_cvt_pk_bf16_f32 v99, v54, v55
    v_exp_f32 v58, v58
    v_exp_f32 v59, v59
    v_mfma_f32_32x32x16_bf16 v[64:79], v[112:115], v[96:99], v[64:79]
    ds_read_b128 v[112:115], v2 offset:2048
    v_mfma_f32_32x32x16_bf16 a[80:95], a[116:119], a[100:103], a[80:95]
    v_exp_f32 v60, v60
    v_exp_f32 v61, v61
    v_exp_f32 v62, v62
    v_exp_f32 v63, v63
    v_cvt_pk_bf16_f32 v100, v56, v57
    v_cvt_pk_bf16_f32 v101, v58, v59
    v_cvt_pk_bf16_f32 v102, v60, v61
    v_cvt_pk_bf16_f32 v103, v62, v63
    s_waitcnt lgkmcnt(2)
    v_mfma_f32_32x32x16_bf16 v[48:63], v[104:107], v[16:19], v[80:95]
    v_exp_f32 v32, v32
    v_exp_f32 v33, v33
    v_exp_f32 v34, v34
    v_exp_f32 v35, v35
    v_mfma_f32_32x32x16_bf16 v[48:63], v[108:111], v[20:23], v[48:63]
    ds_read_b128 v[104:107], v2 offset:8192
    ds_read_b128 v[108:111], v2 offset:9216
    v_exp_f32 v36, v36
    v_exp_f32 v37, v37
    v_exp_f32 v38, v38
    v_exp_f32 v39, v39
    v_smfmac_f32_16x16x64_bf16 v[24:27], v[28:31], v[96:103], v15
    s_waitcnt lgkmcnt(2)
    v_exp_f32 v40, v40
    v_exp_f32 v41, v41
    v_mfma_f32_32x32x16_bf16 v[64:79], v[116:119], v[100:103], v[64:79]
    s_setprio 2
    ds_read_b128 v[116:119], v2 offset:3072
    v_cvt_pk_bf16_f32 v96, v32, v33
    v_cvt_pk_bf16_f32 v97, v34, v35
    v_cvt_pk_bf16_f32 v98, v36, v37
    v_cvt_pk_bf16_f32 v99, v38, v39
    v_exp_f32 v42, v42
    v_exp_f32 v43, v43
    v_mfma_f32_32x32x16_bf16 v[64:79], v[112:115], v[96:99], v[64:79]
    ds_read_b128 v[112:115], v2 offset:6144
    v_accvgpr_read_b32 v120, a80
    v_exp_f32 v44, v44
    v_exp_f32 v45, v45
    v_exp_f32 v46, v46
    v_exp_f32 v47, v47
    v_cvt_pk_bf16_f32 v100, v40, v41
    v_cvt_pk_bf16_f32 v101, v42, v43
    v_cvt_pk_bf16_f32 v102, v44, v45
    v_cvt_pk_bf16_f32 v103, v46, v47
    s_waitcnt lgkmcnt(2)
    v_mfma_f32_32x32x16_bf16 v[32:47], v[104:107], v[16:19], v[80:95]
    v_exp_f32 v48, v48
    v_exp_f32 v49, v49
    v_exp_f32 v50, v50
    v_exp_f32 v51, v51
    v_mfma_f32_32x32x16_bf16 v[32:47], v[108:111], v[20:23], v[32:47]
    ds_read_b128 v[104:107], v2 offset:12288
    ds_read_b128 v[108:111], v2 offset:13312
    v_mfma_f32_32x32x16_bf16 a[80:95], a[112:115], a[104:107], 0
    v_exp_f32 v52, v52
    v_exp_f32 v53, v53
    v_exp_f32 v54, v54
    v_exp_f32 v55, v55
    v_smfmac_f32_16x16x64_bf16 v[24:27], v[28:31], v[96:103], v15
    s_setprio 1
    s_waitcnt lgkmcnt(2)
    v_exp_f32 v56, v56
    v_exp_f32 v57, v57
    v_mfma_f32_32x32x16_bf16 v[64:79], v[116:119], v[100:103], v[64:79]
    ds_read_b128 v[116:119], v2 offset:7168
    v_cvt_pk_bf16_f32 v96, v48, v49
    v_cvt_pk_bf16_f32 v97, v50, v51
    v_cvt_pk_bf16_f32 v98, v52, v53
    v_cvt_pk_bf16_f32 v99, v54, v55
    v_exp_f32 v58, v58
    v_exp_f32 v59, v59
    v_mfma_f32_32x32x16_bf16 v[64:79], v[112:115], v[96:99], v[64:79]
    s_setprio 0
    ds_read_b128 v[112:115], v2 offset:10240
    v_mfma_f32_32x32x16_bf16 a[80:95], a[116:119], a[108:111], a[80:95]
    v_exp_f32 v60, v60
    v_exp_f32 v61, v61
    v_exp_f32 v62, v62
    v_exp_f32 v63, v63
    v_cvt_pk_bf16_f32 v100, v56, v57
    v_cvt_pk_bf16_f32 v101, v58, v59
    v_cvt_pk_bf16_f32 v102, v60, v61
    v_cvt_pk_bf16_f32 v103, v62, v63
    s_waitcnt lgkmcnt(2)
    v_mfma_f32_32x32x16_bf16 v[48:63], v[104:107], v[16:19], v[80:95]
    v_exp_f32 v32, v32
    v_exp_f32 v33, v33
    v_exp_f32 v34, v34
    v_exp_f32 v35, v35
    v_mfma_f32_32x32x16_bf16 v[48:63], v[108:111], v[20:23], v[48:63]
    s_waitcnt vmcnt(6)
    s_barrier
    v_accvgpr_read_b32 v121, a80
    buffer_atomic_add_f32 v120, v1, s[12:15], s53 offen offset:0
    buffer_atomic_add_f32 v121, v1, s[12:15], s53 offen offset:256
    s_setprio 3
    ds_read_b128 v[104:107], v2 offset:16384
    ds_read_b128 v[108:111], v2 offset:17408
    v_exp_f32 v36, v36
    v_exp_f32 v37, v37
    v_exp_f32 v38, v38
    v_exp_f32 v39, v39
    v_smfmac_f32_16x16x64_bf16 v[24:27], v[28:31], v[96:103], v15
    s_waitcnt lgkmcnt(2)
    v_exp_f32 v40, v40
    v_exp_f32 v41, v41
    v_mfma_f32_32x32x16_bf16 v[64:79], v[116:119], v[100:103], v[64:79]
    ds_read_b128 v[116:119], v2 offset:11264
    s_add_u32 m0, s33, 49152
    s_cmp_ge_u32 s22, 15
    s_cselect_b32 s34, 0, 32768
    s_add_u32 s34, s34, s30
    s_add_u32 s34, s34, 458752
    buffer_load_dwordx4 v2, s[12:15], s34 offen offset:0 sc1 lds
    buffer_load_dwordx4 v2, s[12:15], s34 offen offset:1024 sc1 lds
    v_cvt_pk_bf16_f32 v96, v32, v33
    v_cvt_pk_bf16_f32 v97, v34, v35
    v_cvt_pk_bf16_f32 v98, v36, v37
    v_cvt_pk_bf16_f32 v99, v38, v39
    v_exp_f32 v42, v42
    v_exp_f32 v43, v43
    v_mfma_f32_32x32x16_bf16 v[64:79], v[112:115], v[96:99], v[64:79]
    ds_read_b128 v[112:115], v2 offset:14336
    s_add_u32 s58, s46, 16384
    buffer_load_dwordx4 a[64:67], v2, s[12:15], s58 offen offset:0 sc1
    v_exp_f32 v44, v44
    v_exp_f32 v45, v45
    v_exp_f32 v46, v46
    v_exp_f32 v47, v47
    v_cvt_pk_bf16_f32 v100, v40, v41
    v_cvt_pk_bf16_f32 v101, v42, v43
    v_cvt_pk_bf16_f32 v102, v44, v45
    v_cvt_pk_bf16_f32 v103, v46, v47
    s_waitcnt lgkmcnt(2)
    v_mfma_f32_32x32x16_bf16 v[32:47], v[104:107], v[16:19], v[80:95]
    v_exp_f32 v48, v48
    v_exp_f32 v49, v49
    v_exp_f32 v50, v50
    v_exp_f32 v51, v51
    v_mfma_f32_32x32x16_bf16 v[32:47], v[108:111], v[20:23], v[32:47]
    ds_read_b128 v[104:107], v2 offset:20480
    ds_read_b128 v[108:111], v2 offset:21504
    v_exp_f32 v52, v52
    v_exp_f32 v53, v53
    v_exp_f32 v54, v54
    v_exp_f32 v55, v55
    v_smfmac_f32_16x16x64_bf16 v[24:27], v[28:31], v[96:103], v15
    s_waitcnt lgkmcnt(2)
    v_exp_f32 v56, v56
    v_exp_f32 v57, v57
    v_mfma_f32_32x32x16_bf16 v[64:79], v[116:119], v[100:103], v[64:79]
    ds_read_b128 v[116:119], v2 offset:15360
    v_cvt_pk_bf16_f32 v96, v48, v49
    v_cvt_pk_bf16_f32 v97, v50, v51
    v_cvt_pk_bf16_f32 v98, v52, v53
    v_cvt_pk_bf16_f32 v99, v54, v55
    v_exp_f32 v58, v58
    v_exp_f32 v59, v59
    v_mfma_f32_32x32x16_bf16 v[64:79], v[112:115], v[96:99], v[64:79]
    ds_read_b128 v[112:115], v2 offset:18432
    buffer_load_dwordx4 a[68:71], v2, s[12:15], s58 offen offset:1024 sc1
    v_exp_f32 v60, v60
    v_exp_f32 v61, v61
    v_exp_f32 v62, v62
    v_exp_f32 v63, v63
    v_cvt_pk_bf16_f32 v100, v56, v57
    v_cvt_pk_bf16_f32 v101, v58, v59
    v_cvt_pk_bf16_f32 v102, v60, v61
    v_cvt_pk_bf16_f32 v103, v62, v63
    s_waitcnt lgkmcnt(2)
    v_mfma_f32_32x32x16_bf16 v[48:63], v[104:107], v[16:19], v[80:95]
    v_exp_f32 v32, v32
    v_exp_f32 v33, v33
    v_exp_f32 v34, v34
    v_exp_f32 v35, v35
    v_mfma_f32_32x32x16_bf16 v[48:63], v[108:111], v[20:23], v[48:63]
    ds_read_b128 v[104:107], v2 offset:24576
    ds_read_b128 v[108:111], v2 offset:25600
    v_exp_f32 v36, v36
    v_exp_f32 v37, v37
    v_exp_f32 v38, v38
    v_exp_f32 v39, v39
    v_smfmac_f32_16x16x64_bf16 v[24:27], v[28:31], v[96:103], v15
    s_waitcnt lgkmcnt(2)
    v_exp_f32 v40, v40
    v_exp_f32 v41, v41
    v_mfma_f32_32x32x16_bf16 v[64:79], v[116:119], v[100:103], v[64:79]
    s_setprio 2
    ds_read_b128 v[116:119], v2 offset:19456
    v_cvt_pk_bf16_f32 v96, v32, v33
    v_cvt_pk_bf16_f32 v97, v34, v35
    v_cvt_pk_bf16_f32 v98, v36, v37
    v_cvt_pk_bf16_f32 v99, v38, v39
    v_exp_f32 v42, v42
    v_exp_f32 v43, v43
    v_mfma_f32_32x32x16_bf16 v[64:79], v[112:115], v[96:99], v[64:79]
    ds_read_b128 v[112:115], v2 offset:22528
    buffer_load_dwordx4 a[72:75], v2, s[12:15], s58 offen offset:2048 sc1
    v_exp_f32 v44, v44
    v_exp_f32 v45, v45
    v_exp_f32 v46, v46
    v_exp_f32 v47, v47
    v_cvt_pk_bf16_f32 v100, v40, v41
    v_cvt_pk_bf16_f32 v101, v42, v43
    v_cvt_pk_bf16_f32 v102, v44, v45
    v_cvt_pk_bf16_f32 v103, v46, v47
    s_waitcnt lgkmcnt(2)
    v_mfma_f32_32x32x16_bf16 v[32:47], v[104:107], v[16:19], v[80:95]
    v_exp_f32 v48, v48
    v_exp_f32 v49, v49
    v_exp_f32 v50, v50
    v_exp_f32 v51, v51
    v_mfma_f32_32x32x16_bf16 v[32:47], v[108:111], v[20:23], v[32:47]
    ds_read_b128 v[104:107], v2 offset:28672
    ds_read_b128 v[108:111], v2 offset:29696
    v_exp_f32 v52, v52
    v_exp_f32 v53, v53
    v_exp_f32 v54, v54
    v_exp_f32 v55, v55
    v_smfmac_f32_16x16x64_bf16 v[24:27], v[28:31], v[96:103], v15
    s_setprio 1
    s_waitcnt lgkmcnt(2)
    v_exp_f32 v56, v56
    v_exp_f32 v57, v57
    v_mfma_f32_32x32x16_bf16 v[64:79], v[116:119], v[100:103], v[64:79]
    ds_read_b128 v[116:119], v2 offset:23552
    v_cvt_pk_bf16_f32 v96, v48, v49
    v_cvt_pk_bf16_f32 v97, v50, v51
    v_cvt_pk_bf16_f32 v98, v52, v53
    v_cvt_pk_bf16_f32 v99, v54, v55
    v_exp_f32 v58, v58
    v_exp_f32 v59, v59
    v_mfma_f32_32x32x16_bf16 v[64:79], v[112:115], v[96:99], v[64:79]
    s_setprio 0
    ds_read_b128 v[112:115], v2 offset:26624
    buffer_load_dwordx4 a[76:79], v2, s[12:15], s58 offen offset:3072 sc1
    v_exp_f32 v60, v60
    v_exp_f32 v61, v61
    v_exp_f32 v62, v62
    v_exp_f32 v63, v63
    v_cvt_pk_bf16_f32 v100, v56, v57
    v_cvt_pk_bf16_f32 v101, v58, v59
    v_cvt_pk_bf16_f32 v102, v60, v61
    v_cvt_pk_bf16_f32 v103, v62, v63
    s_waitcnt lgkmcnt(2)
    v_mfma_f32_32x32x16_bf16 v[48:63], v[104:107], v[16:19], v[80:95]
    v_exp_f32 v32, v32
    v_exp_f32 v33, v33
    v_exp_f32 v34, v34
    v_exp_f32 v35, v35
    v_mfma_f32_32x32x16_bf16 v[48:63], v[108:111], v[20:23], v[48:63]
    s_waitcnt vmcnt(8)
    s_barrier
    s_setprio 3
    ds_read_b128 v[104:107], v2 offset:32768
    ds_read_b128 v[108:111], v2 offset:33792
    s_add_u32 s58, s46, 20480
    buffer_load_dwordx4 a[80:83], v2, s[12:15], s58 offen offset:0 sc1
    v_exp_f32 v36, v36
    v_exp_f32 v37, v37
    v_exp_f32 v38, v38
    v_exp_f32 v39, v39
    v_smfmac_f32_16x16x64_bf16 v[24:27], v[28:31], v[96:103], v15
    s_waitcnt lgkmcnt(2)
    v_exp_f32 v40, v40
    v_exp_f32 v41, v41
    v_mfma_f32_32x32x16_bf16 v[64:79], v[116:119], v[100:103], v[64:79]
    ds_read_b128 v[116:119], v2 offset:27648
    v_cvt_pk_bf16_f32 v96, v32, v33
    v_cvt_pk_bf16_f32 v97, v34, v35
    v_cvt_pk_bf16_f32 v98, v36, v37
    v_cvt_pk_bf16_f32 v99, v38, v39
    v_exp_f32 v42, v42
    v_exp_f32 v43, v43
    v_mfma_f32_32x32x16_bf16 v[64:79], v[112:115], v[96:99], v[64:79]
    ds_read_b128 v[112:115], v2 offset:30720
    buffer_load_dwordx4 a[84:87], v2, s[12:15], s58 offen offset:1024 sc1
    v_exp_f32 v44, v44
    v_exp_f32 v45, v45
    v_exp_f32 v46, v46
    v_exp_f32 v47, v47
    v_cvt_pk_bf16_f32 v100, v40, v41
    v_cvt_pk_bf16_f32 v101, v42, v43
    v_cvt_pk_bf16_f32 v102, v44, v45
    v_cvt_pk_bf16_f32 v103, v46, v47
    s_waitcnt lgkmcnt(2)
    v_mfma_f32_32x32x16_bf16 v[32:47], v[104:107], v[16:19], v[80:95]
    v_exp_f32 v48, v48
    v_exp_f32 v49, v49
    v_exp_f32 v50, v50
    v_exp_f32 v51, v51
    v_mfma_f32_32x32x16_bf16 v[32:47], v[108:111], v[20:23], v[32:47]
    ds_read_b128 v[104:107], v2 offset:36864
    ds_read_b128 v[108:111], v2 offset:37888
    buffer_load_dwordx4 a[88:91], v2, s[12:15], s58 offen offset:2048 sc1
    v_exp_f32 v52, v52
    v_exp_f32 v53, v53
    v_exp_f32 v54, v54
    v_exp_f32 v55, v55
    v_smfmac_f32_16x16x64_bf16 v[24:27], v[28:31], v[96:103], v15
    s_waitcnt lgkmcnt(2)
    v_exp_f32 v56, v56
    v_exp_f32 v57, v57
    v_mfma_f32_32x32x16_bf16 v[64:79], v[116:119], v[100:103], v[64:79]
    ds_read_b128 v[116:119], v2 offset:31744
    v_cvt_pk_bf16_f32 v96, v48, v49
    v_cvt_pk_bf16_f32 v97, v50, v51
    v_cvt_pk_bf16_f32 v98, v52, v53
    v_cvt_pk_bf16_f32 v99, v54, v55
    v_exp_f32 v58, v58
    v_exp_f32 v59, v59
    v_mfma_f32_32x32x16_bf16 v[64:79], v[112:115], v[96:99], v[64:79]
    ds_read_b128 v[112:115], v2 offset:34816
    buffer_load_dwordx4 a[92:95], v2, s[12:15], s58 offen offset:3072 sc1
    v_exp_f32 v60, v60
    v_exp_f32 v61, v61
    v_exp_f32 v62, v62
    v_exp_f32 v63, v63
    v_cvt_pk_bf16_f32 v100, v56, v57
    v_cvt_pk_bf16_f32 v101, v58, v59
    v_cvt_pk_bf16_f32 v102, v60, v61
    v_cvt_pk_bf16_f32 v103, v62, v63
    s_waitcnt lgkmcnt(2)
    v_mfma_f32_32x32x16_bf16 v[48:63], v[104:107], v[16:19], v[80:95]
    v_exp_f32 v32, v32
    v_exp_f32 v33, v33
    v_exp_f32 v34, v34
    v_exp_f32 v35, v35
    v_mfma_f32_32x32x16_bf16 v[48:63], v[108:111], v[20:23], v[48:63]
    ds_read_b128 v[104:107], v2 offset:40960
    ds_read_b128 v[108:111], v2 offset:41984
    s_add_u32 s58, s46, 24576
    buffer_load_dwordx4 a[96:99], v2, s[12:15], s58 offen offset:0 sc1
    v_exp_f32 v36, v36
    v_exp_f32 v37, v37
    v_exp_f32 v38, v38
    v_exp_f32 v39, v39
    v_smfmac_f32_16x16x64_bf16 v[24:27], v[28:31], v[96:103], v15
    s_waitcnt lgkmcnt(2)
    v_exp_f32 v40, v40
    v_exp_f32 v41, v41
    v_mfma_f32_32x32x16_bf16 v[64:79], v[116:119], v[100:103], v[64:79]
    s_setprio 2
    ds_read_b128 v[116:119], v2 offset:35840
    v_cvt_pk_bf16_f32 v96, v32, v33
    v_cvt_pk_bf16_f32 v97, v34, v35
    v_cvt_pk_bf16_f32 v98, v36, v37
    v_cvt_pk_bf16_f32 v99, v38, v39
    v_exp_f32 v42, v42
    v_exp_f32 v43, v43
    v_mfma_f32_32x32x16_bf16 v[64:79], v[112:115], v[96:99], v[64:79]
    ds_read_b128 v[112:115], v2 offset:38912
    buffer_load_dwordx4 a[100:103], v2, s[12:15], s58 offen offset:1024 sc1
    v_exp_f32 v44, v44
    v_exp_f32 v45, v45
    v_exp_f32 v46, v46
    v_exp_f32 v47, v47
    v_cvt_pk_bf16_f32 v100, v40, v41
    v_cvt_pk_bf16_f32 v101, v42, v43
    v_cvt_pk_bf16_f32 v102, v44, v45
    v_cvt_pk_bf16_f32 v103, v46, v47
    s_waitcnt lgkmcnt(2)
    v_mfma_f32_32x32x16_bf16 v[32:47], v[104:107], v[16:19], v[80:95]
    v_exp_f32 v48, v48
    v_exp_f32 v49, v49
    v_exp_f32 v50, v50
    v_exp_f32 v51, v51
    v_mfma_f32_32x32x16_bf16 v[32:47], v[108:111], v[20:23], v[32:47]
    ds_read_b128 v[104:107], v2 offset:45056
    ds_read_b128 v[108:111], v2 offset:46080
    buffer_load_dwordx4 a[104:107], v2, s[12:15], s58 offen offset:2048 sc1
    v_exp_f32 v52, v52
    v_exp_f32 v53, v53
    v_exp_f32 v54, v54
    v_exp_f32 v55, v55
    v_smfmac_f32_16x16x64_bf16 v[24:27], v[28:31], v[96:103], v15
    s_setprio 1
    s_waitcnt lgkmcnt(2)
    v_exp_f32 v56, v56
    v_exp_f32 v57, v57
    v_mfma_f32_32x32x16_bf16 v[64:79], v[116:119], v[100:103], v[64:79]
    ds_read_b128 v[116:119], v2 offset:39936
    v_cvt_pk_bf16_f32 v96, v48, v49
    v_cvt_pk_bf16_f32 v97, v50, v51
    v_cvt_pk_bf16_f32 v98, v52, v53
    v_cvt_pk_bf16_f32 v99, v54, v55
    v_exp_f32 v58, v58
    v_exp_f32 v59, v59
    v_mfma_f32_32x32x16_bf16 v[64:79], v[112:115], v[96:99], v[64:79]
    s_setprio 0
    ds_read_b128 v[112:115], v2 offset:43008
    buffer_load_dwordx4 a[108:111], v2, s[12:15], s58 offen offset:3072 sc1
    v_exp_f32 v60, v60
    v_exp_f32 v61, v61
    v_exp_f32 v62, v62
    v_exp_f32 v63, v63
    v_cvt_pk_bf16_f32 v100, v56, v57
    v_cvt_pk_bf16_f32 v101, v58, v59
    v_cvt_pk_bf16_f32 v102, v60, v61
    v_cvt_pk_bf16_f32 v103, v62, v63
    s_waitcnt lgkmcnt(2)
    v_mfma_f32_32x32x16_bf16 v[48:63], v[104:107], v[16:19], v[80:95]
    v_exp_f32 v32, v32
    v_exp_f32 v33, v33
    v_exp_f32 v34, v34
    v_exp_f32 v35, v35
    v_mfma_f32_32x32x16_bf16 v[48:63], v[108:111], v[20:23], v[48:63]
    s_waitcnt vmcnt(12)
    s_barrier
    buffer_store_dword v6, v3, s[12:15], s55 offen sc1
    s_setprio 0
    ds_read_b128 v[104:107], v2 offset:49152
    ds_read_b128 v[108:111], v2 offset:50176
    v_exp_f32 v36, v36
    v_exp_f32 v37, v37
    v_exp_f32 v38, v38
    v_exp_f32 v39, v39
    v_smfmac_f32_16x16x64_bf16 v[24:27], v[28:31], v[96:103], v15
    s_waitcnt lgkmcnt(2)
    v_exp_f32 v40, v40
    v_exp_f32 v41, v41
    v_mfma_f32_32x32x16_bf16 v[64:79], v[116:119], v[100:103], v[64:79]
    ds_read_b128 v[116:119], v2 offset:44032
    v_cvt_pk_bf16_f32 v96, v32, v33
    v_cvt_pk_bf16_f32 v97, v34, v35
    v_cvt_pk_bf16_f32 v98, v36, v37
    v_cvt_pk_bf16_f32 v99, v38, v39
    v_exp_f32 v42, v42
    v_exp_f32 v43, v43
    v_mfma_f32_32x32x16_bf16 v[64:79], v[112:115], v[96:99], v[64:79]
    ds_read_b128 v[112:115], v2 offset:47104
    s_add_u32 s58, s46, 28672
    buffer_load_dwordx4 a[112:115], v2, s[12:15], s58 offen offset:0 sc1
    v_exp_f32 v44, v44
    v_exp_f32 v45, v45
    v_exp_f32 v46, v46
    v_exp_f32 v47, v47
    v_cvt_pk_bf16_f32 v100, v40, v41
    v_cvt_pk_bf16_f32 v101, v42, v43
    v_cvt_pk_bf16_f32 v102, v44, v45
    v_cvt_pk_bf16_f32 v103, v46, v47
    s_waitcnt lgkmcnt(2)
    v_mfma_f32_32x32x16_bf16 v[32:47], v[104:107], v[16:19], v[80:95]
    v_exp_f32 v48, v48
    v_exp_f32 v49, v49
    v_exp_f32 v50, v50
    v_exp_f32 v51, v51
    v_mfma_f32_32x32x16_bf16 v[32:47], v[108:111], v[20:23], v[32:47]
    ds_read_b128 v[104:107], v2 offset:53248
    ds_read_b128 v[108:111], v2 offset:54272
    v_exp_f32 v52, v52
    v_exp_f32 v53, v53
    v_exp_f32 v54, v54
    v_exp_f32 v55, v55
    v_smfmac_f32_16x16x64_bf16 v[24:27], v[28:31], v[96:103], v15
    s_waitcnt lgkmcnt(2)
    v_exp_f32 v56, v56
    v_exp_f32 v57, v57
    v_mfma_f32_32x32x16_bf16 v[64:79], v[116:119], v[100:103], v[64:79]
    ds_read_b128 v[116:119], v2 offset:48128
    v_cvt_pk_bf16_f32 v96, v48, v49
    v_cvt_pk_bf16_f32 v97, v50, v51
    v_cvt_pk_bf16_f32 v98, v52, v53
    v_cvt_pk_bf16_f32 v99, v54, v55
    v_exp_f32 v58, v58
    v_exp_f32 v59, v59
    v_mfma_f32_32x32x16_bf16 v[64:79], v[112:115], v[96:99], v[64:79]
    ds_read_b128 v[112:115], v2 offset:51200
    buffer_load_dwordx4 a[116:119], v2, s[12:15], s58 offen offset:1024 sc1
    v_exp_f32 v60, v60
    v_exp_f32 v61, v61
    v_exp_f32 v62, v62
    v_exp_f32 v63, v63
    v_cvt_pk_bf16_f32 v100, v56, v57
    v_cvt_pk_bf16_f32 v101, v58, v59
    v_cvt_pk_bf16_f32 v102, v60, v61
    v_cvt_pk_bf16_f32 v103, v62, v63
    s_waitcnt lgkmcnt(2)
    v_mfma_f32_32x32x16_bf16 v[48:63], v[104:107], v[16:19], v[80:95]
    v_exp_f32 v32, v32
    v_exp_f32 v33, v33
    v_exp_f32 v34, v34
    v_exp_f32 v35, v35
    v_mfma_f32_32x32x16_bf16 v[48:63], v[108:111], v[20:23], v[48:63]
    ds_read_b128 v[104:107], v2 offset:57344
    ds_read_b128 v[108:111], v2 offset:58368
    v_exp_f32 v36, v36
    v_exp_f32 v37, v37
    v_exp_f32 v38, v38
    v_exp_f32 v39, v39
    v_smfmac_f32_16x16x64_bf16 v[24:27], v[28:31], v[96:103], v15
    s_waitcnt lgkmcnt(2)
    v_exp_f32 v40, v40
    v_exp_f32 v41, v41
    v_mfma_f32_32x32x16_bf16 v[64:79], v[116:119], v[100:103], v[64:79]
    ds_read_b128 v[116:119], v2 offset:52224
    v_cvt_pk_bf16_f32 v96, v32, v33
    v_cvt_pk_bf16_f32 v97, v34, v35
    v_cvt_pk_bf16_f32 v98, v36, v37
    v_cvt_pk_bf16_f32 v99, v38, v39
    v_exp_f32 v42, v42
    v_exp_f32 v43, v43
    v_mfma_f32_32x32x16_bf16 v[64:79], v[112:115], v[96:99], v[64:79]
    ds_read_b128 v[112:115], v2 offset:55296
    buffer_load_dwordx4 a[120:123], v2, s[12:15], s58 offen offset:2048 sc1
    v_exp_f32 v44, v44
    v_exp_f32 v45, v45
    v_exp_f32 v46, v46
    v_exp_f32 v47, v47
    v_cvt_pk_bf16_f32 v100, v40, v41
    v_cvt_pk_bf16_f32 v101, v42, v43
    v_cvt_pk_bf16_f32 v102, v44, v45
    v_cvt_pk_bf16_f32 v103, v46, v47
    s_waitcnt lgkmcnt(2)
    v_mfma_f32_32x32x16_bf16 v[32:47], v[104:107], v[16:19], v[80:95]
    v_exp_f32 v48, v48
    v_exp_f32 v49, v49
    v_exp_f32 v50, v50
    v_exp_f32 v51, v51
    v_mfma_f32_32x32x16_bf16 v[32:47], v[108:111], v[20:23], v[32:47]
    ds_read_b128 v[104:107], v2 offset:61440
    ds_read_b128 v[108:111], v2 offset:62464
    v_exp_f32 v52, v52
    v_exp_f32 v53, v53
    v_exp_f32 v54, v54
    v_exp_f32 v55, v55
    v_smfmac_f32_16x16x64_bf16 v[24:27], v[28:31], v[96:103], v15
    s_waitcnt lgkmcnt(2)
    v_exp_f32 v56, v56
    v_exp_f32 v57, v57
    v_mfma_f32_32x32x16_bf16 v[64:79], v[116:119], v[100:103], v[64:79]
    ds_read_b128 v[116:119], v2 offset:56320
    v_cvt_pk_bf16_f32 v96, v48, v49
    v_cvt_pk_bf16_f32 v97, v50, v51
    v_cvt_pk_bf16_f32 v98, v52, v53
    v_cvt_pk_bf16_f32 v99, v54, v55
    v_exp_f32 v58, v58
    v_exp_f32 v59, v59
    v_mfma_f32_32x32x16_bf16 v[64:79], v[112:115], v[96:99], v[64:79]
    ds_read_b128 v[112:115], v2 offset:59392
    buffer_load_dwordx4 a[124:127], v2, s[12:15], s58 offen offset:3072 sc1
    v_exp_f32 v60, v60
    v_exp_f32 v61, v61
    v_exp_f32 v62, v62
    v_exp_f32 v63, v63
    v_cvt_pk_bf16_f32 v100, v56, v57
    v_cvt_pk_bf16_f32 v101, v58, v59
    v_cvt_pk_bf16_f32 v102, v60, v61
    v_cvt_pk_bf16_f32 v103, v62, v63
    s_waitcnt lgkmcnt(2)
    v_mfma_f32_32x32x16_bf16 v[48:63], v[104:107], v[16:19], v[80:95]
    v_exp_f32 v32, v32
    v_exp_f32 v33, v33
    v_exp_f32 v34, v34
    v_exp_f32 v35, v35
    v_mfma_f32_32x32x16_bf16 v[48:63], v[108:111], v[20:23], v[48:63]
    v_exp_f32 v36, v36
    v_exp_f32 v37, v37
    v_exp_f32 v38, v38
    v_exp_f32 v39, v39
    v_smfmac_f32_16x16x64_bf16 v[24:27], v[28:31], v[96:103], v15
    s_waitcnt lgkmcnt(0)
    v_exp_f32 v40, v40
    v_exp_f32 v41, v41
    v_mfma_f32_32x32x16_bf16 v[64:79], v[116:119], v[100:103], v[64:79]
    ds_read_b128 v[116:119], v2 offset:60416
    v_cvt_pk_bf16_f32 v96, v32, v33
    v_cvt_pk_bf16_f32 v97, v34, v35
    v_cvt_pk_bf16_f32 v98, v36, v37
    v_cvt_pk_bf16_f32 v99, v38, v39
    v_exp_f32 v42, v42
    v_exp_f32 v43, v43
    v_mfma_f32_32x32x16_bf16 v[64:79], v[112:115], v[96:99], v[64:79]
    ds_read_b128 v[112:115], v2 offset:63488
    v_exp_f32 v44, v44
    v_exp_f32 v45, v45
    v_exp_f32 v46, v46
    v_exp_f32 v47, v47
    v_cvt_pk_bf16_f32 v100, v40, v41
    v_cvt_pk_bf16_f32 v101, v42, v43
    v_cvt_pk_bf16_f32 v102, v44, v45
    v_cvt_pk_bf16_f32 v103, v46, v47
    v_exp_f32 v48, v48
    v_exp_f32 v49, v49
    v_exp_f32 v50, v50
    v_exp_f32 v51, v51
    v_exp_f32 v52, v52
    v_exp_f32 v53, v53
    v_exp_f32 v54, v54
    v_exp_f32 v55, v55
    v_smfmac_f32_16x16x64_bf16 v[24:27], v[28:31], v[96:103], v15
    s_waitcnt lgkmcnt(0)
    v_exp_f32 v56, v56
    v_exp_f32 v57, v57
    v_mfma_f32_32x32x16_bf16 v[64:79], v[116:119], v[100:103], v[64:79]
    ds_read_b128 v[116:119], v2 offset:64512
    v_cvt_pk_bf16_f32 v96, v48, v49
    v_cvt_pk_bf16_f32 v97, v50, v51
    v_cvt_pk_bf16_f32 v98, v52, v53
    v_cvt_pk_bf16_f32 v99, v54, v55
    v_exp_f32 v58, v58
    v_exp_f32 v59, v59
    v_mfma_f32_32x32x16_bf16 v[64:79], v[112:115], v[96:99], v[64:79]
    v_exp_f32 v60, v60
    v_exp_f32 v61, v61
    v_exp_f32 v62, v62
    v_exp_f32 v63, v63
    v_cvt_pk_bf16_f32 v100, v56, v57
    v_cvt_pk_bf16_f32 v101, v58, v59
    v_cvt_pk_bf16_f32 v102, v60, v61
    v_cvt_pk_bf16_f32 v103, v62, v63
    s_waitcnt lgkmcnt(0)
    s_nop 0
    v_mfma_f32_32x32x16_bf16 v[64:79], v[116:119], v[100:103], v[64:79]
    v_smfmac_f32_16x16x64_bf16 v[24:27], v[28:31], v[96:103], v15
    s_mov_b32 s59, 0
    s_lshr_b32 s31, s22, 1
    s_lshl_b32 s31, s31, 3
    s_add_u32 s31, s31, s20
    s_lshl_b32 s31, s31, 16
    s_lshl_b32 s29, s21, 1
    s_and_b32 s27, s22, 1
    s_add_u32 s29, s29, s27
    s_lshl_b32 s27, s29, 11
    s_add_u32 s31, s31, s27
    s_add_u32 s31, s31, 13631488
    v_add_f32 v4, v24, v25
L_back:
    v_rcp_f32 v6, v4
    v_mov_b32 v5, 0x5d800000
    v_pk_mul_f32 v[64:65], v[64:65], v[6:7] op_sel_hi:[1,0]
    v_pk_mul_f32 v[66:67], v[66:67], v[6:7] op_sel_hi:[1,0]
    v_pk_mul_f32 v[68:69], v[68:69], v[6:7] op_sel_hi:[1,0]
    v_pk_mul_f32 v[70:71], v[70:71], v[6:7] op_sel_hi:[1,0]
    v_pk_mul_f32 v[72:73], v[72:73], v[6:7] op_sel_hi:[1,0]
    v_pk_mul_f32 v[74:75], v[74:75], v[6:7] op_sel_hi:[1,0]
    v_pk_mul_f32 v[76:77], v[76:77], v[6:7] op_sel_hi:[1,0]
    v_pk_mul_f32 v[78:79], v[78:79], v[6:7] op_sel_hi:[1,0]
    v_cvt_pk_bf16_f32 v32, v64, v65
    v_cvt_pk_bf16_f32 v33, v66, v67
    v_cvt_pk_bf16_f32 v34, v68, v69
    v_cvt_pk_bf16_f32 v35, v70, v71
    v_cvt_pk_bf16_f32 v36, v72, v73
    v_cvt_pk_bf16_f32 v37, v74, v75
    v_cvt_pk_bf16_f32 v38, v76, v77
    v_cvt_pk_bf16_f32 v39, v78, v79
    buffer_store_dwordx4 v[32:35], v2, s[12:15], s31 offen sc1
    buffer_store_dwordx4 v[36:39], v2, s[12:15], s31 offen offset:1024 sc1
    v_cmp_nlt_f32 vcc, v4, v5
    v_max3_f32 v5, |v64|, |v65|, |v66|
    v_max3_f32 v5, v5, |v67|, |v68|
    v_max3_f32 v5, v5, |v69|, |v70|
    v_max3_f32 v5, v5, |v71|, |v72|
    v_max3_f32 v5, v5, |v73|, |v74|
    v_max3_f32 v5, v5, |v75|, |v76|
    v_max3_f32 v5, v5, |v77|, |v78|
    v_max_f32 v5, |v79|, v5
    v_mov_b32 v7, 0x7f61b1e6
    v_cmp_nlt_f32 s[26:27], v5, v7
    v_cmp_u_f32 s[40:41], v64, v65
    v_cmp_u_f32 s[42:43], v66, v67
    s_nop 0
    s_or_b64 vcc, vcc, s[40:41]
    s_or_b64 vcc, vcc, s[42:43]
    v_cmp_u_f32 s[40:41], v68, v69
    v_cmp_u_f32 s[42:43], v70, v71
    s_nop 0
    s_or_b64 vcc, vcc, s[40:41]
    s_or_b64 vcc, vcc, s[42:43]
    v_cmp_u_f32 s[40:41], v72, v73
    v_cmp_u_f32 s[42:43], v74, v75
    s_nop 0
    s_or_b64 vcc, vcc, s[40:41]
    s_or_b64 vcc, vcc, s[42:43]
    v_cmp_u_f32 s[40:41], v76, v77
    v_cmp_u_f32 s[42:43], v78, v79
    s_nop 0
    s_or_b64 vcc, vcc, s[40:41]
    s_or_b64 vcc, vcc, s[42:43]
    s_or_b64 vcc, vcc, s[26:27]
    s_cmp_lg_u64 vcc, 0
    s_cselect_b32 s28, 1, 0
    s_andn2_b32 s28, s28, s59
    s_lshl_b32 s27, s20, 2
    s_add_u32 s27, s27, 0
    v_mov_b32 v6, s27
    v_mov_b32 v7, s28
    ds_write_b32 v6, v7
    s_mov_b32 s16, s80
    s_mov_b32 s17, s81
    s_mov_b32 s18, 0x400000
    s_mov_b32 s19, 0x20000
    s_mov_b32 s61, 0
    v_and_b32 v6, 7, v0
    v_lshlrev_b32 v6, 2, v6
    v_add_u32 v6, 0, v6
    s_lshr_b32 s53, s20, 2
    s_lshl_b32 s54, s38, 1
    s_add_u32 s54, s54, s53
    s_lshl_b32 s55, s54, 5
    v_and_b32 v4, 31, v0
    v_add_u32 v4, s55, v4
    v_lshrrev_b32 v5, 5, v0
    v_lshlrev_b32 v5, 5, v5
    v_lshl_add_u32 v3, v4, 11, v5
    s_lshl_b32 s56, s39, 8
    s_and_b32 s57, s20, 3
    s_lshl_b32 s57, s57, 6
    s_add_u32 s56, s56, s57
    v_add_u32 v3, s56, v3
    v_lshlrev_b32 v5, 3, v4
    buffer_load_dwordx4 v[104:107], v3, s[4:7], 0 offen
    buffer_load_dwordx4 v[108:111], v3, s[4:7], 0 offen offset:16
    buffer_load_dwordx2 v[8:9], v5, s[12:15], s61 offen sc1
    s_waitcnt lgkmcnt(0)
    s_barrier
    ds_read_b32 v7, v6
    s_waitcnt lgkmcnt(0)
    v_cmp_ne_u32 vcc, 0, v7
    s_nop 1
    s_cmp_lg_u64 vcc, 0
    s_cbranch_scc1 L_safe
    s_lshr_b32 s36, s22, 1
    s_lshl_b32 s36, s36, 5
    s_add_u32 s36, s36, s29
    s_lshl_b32 s36, s36, 2
    s_add_u32 s36, s36, 458752
    s_cmp_lg_u32 s20, 0
    s_cselect_b32 s36, 0x7ffffff0, s36
    v_mov_b32 v5, s23
    v_mov_b32 v6, 0
    s_mov_b64 exec, 1
    s_waitcnt vmcnt(3)
    s_barrier
    buffer_store_dword v5, v6, s[12:15], s36 offen sc1
    s_mov_b64 exec, -1
    s_and_b32 s63, s62, 0xffff
    s_sub_u32 s63, 2047, s63
    s_lshr_b32 s63, s63, 5
    s_lshl_b32 s37, s38, 1
    s_cmp_eq_u32 s63, s37
    s_cselect_b32 s37, 4, 0
    s_lshl_b32 s58, s38, 17
    s_add_u32 s58, s58, 13631488
    s_mov_b32 s35, 1
    s_cmp_eq_u32 s20, s37
    s_cbranch_scc1 L_33
    s_waitcnt vmcnt(1)
    v_lshlrev_b32 v16, 16, v104
    v_and_b32 v17, 0xffff0000, v104
    v_lshlrev_b32 v18, 16, v105
    v_and_b32 v19, 0xffff0000, v105
    v_lshlrev_b32 v20, 16, v106
    v_and_b32 v21, 0xffff0000, v106
    v_lshlrev_b32 v22, 16, v107
    v_and_b32 v23, 0xffff0000, v107
    v_lshlrev_b32 v24, 16, v108
    v_and_b32 v25, 0xffff0000, v108
    v_lshlrev_b32 v26, 16, v109
    v_and_b32 v27, 0xffff0000, v109
    v_lshlrev_b32 v28, 16, v110
    v_and_b32 v29, 0xffff0000, v110
    v_lshlrev_b32 v30, 16, v111
    v_and_b32 v31, 0xffff0000, v111
    v_sub_f32 v4, v16, v8
    v_sub_f32 v5, v17, v8
    v_cvt_pk_bf16_f32 v4, v4, v5
    v_and_b32 v5, 0xffff0000, v4
    v_lshlrev_b32 v4, 16, v4
    v_mul_f32 v4, v4, v9
    v_mul_f32 v5, v5, v9
    v_cvt_pk_bf16_f32 v4, v4, v5
    v_and_b32 v113, 0xffff0000, v4
    v_lshlrev_b32 v112, 16, v4
    v_sub_f32 v4, v18, v8
    v_sub_f32 v5, v19, v8
    v_cvt_pk_bf16_f32 v4, v4, v5
    v_and_b32 v5, 0xffff0000, v4
    v_lshlrev_b32 v4, 16, v4
    v_mul_f32 v4, v4, v9
    v_mul_f32 v5, v5, v9
    v_cvt_pk_bf16_f32 v4, v4, v5
    v_and_b32 v115, 0xffff0000, v4
    v_lshlrev_b32 v114, 16, v4
    v_sub_f32 v4, v20, v8
    v_sub_f32 v5, v21, v8
    v_cvt_pk_bf16_f32 v4, v4, v5
    v_and_b32 v5, 0xffff0000, v4
    v_lshlrev_b32 v4, 16, v4
    v_mul_f32 v4, v4, v9
    v_mul_f32 v5, v5, v9
    v_cvt_pk_bf16_f32 v4, v4, v5
    v_and_b32 v117, 0xffff0000, v4
    v_lshlrev_b32 v116, 16, v4
    v_sub_f32 v4, v22, v8
    v_sub_f32 v5, v23, v8
    v_cvt_pk_bf16_f32 v4, v4, v5
    v_and_b32 v5, 0xffff0000, v4
    v_lshlrev_b32 v4, 16, v4
    v_mul_f32 v4, v4, v9
    v_mul_f32 v5, v5, v9
    v_cvt_pk_bf16_f32 v4, v4, v5
    v_and_b32 v119, 0xffff0000, v4
    v_lshlrev_b32 v118, 16, v4
    v_sub_f32 v4, v24, v8
    v_sub_f32 v5, v25, v8
    v_cvt_pk_bf16_f32 v4, v4, v5
    v_and_b32 v5, 0xffff0000, v4
    v_lshlrev_b32 v4, 16, v4
    v_mul_f32 v4, v4, v9
    v_mul_f32 v5, v5, v9
    v_cvt_pk_bf16_f32 v4, v4, v5
    v_and_b32 v121, 0xffff0000, v4
    v_lshlrev_b32 v120, 16, v4
    v_sub_f32 v4, v26, v8
    v_sub_f32 v5, v27, v8
    v_cvt_pk_bf16_f32 v4, v4, v5
    v_and_b32 v5, 0xffff0000, v4
    v_lshlrev_b32 v4, 16, v4
    v_mul_f32 v4, v4, v9
    v_mul_f32 v5, v5, v9
    v_cvt_pk_bf16_f32 v4, v4, v5
    v_and_b32 v123, 0xffff0000, v4
    v_lshlrev_b32 v122, 16, v4
    v_sub_f32 v4, v28, v8
    v_sub_f32 v5, v29, v8
    v_cvt_pk_bf16_f32 v4, v4, v5
    v_and_b32 v5, 0xffff0000, v4
    v_lshlrev_b32 v4, 16, v4
    v_mul_f32 v4, v4, v9
    v_mul_f32 v5, v5, v9
    v_cvt_pk_bf16_f32 v4, v4, v5
    v_and_b32 v125, 0xffff0000, v4
    v_lshlrev_b32 v124, 16, v4
    v_sub_f32 v4, v30, v8
    v_sub_f32 v5, v31, v8
    v_cvt_pk_bf16_f32 v4, v4, v5
    v_and_b32 v5, 0xffff0000, v4
    v_lshlrev_b32 v4, 16, v4
    v_mul_f32 v4, v4, v9
    v_mul_f32 v5, v5, v9
    v_cvt_pk_bf16_f32 v4, v4, v5
    v_and_b32 v127, 0xffff0000, v4
    v_lshlrev_b32 v126, 16, v4
    v_add_f32 v16, v16, v112
    v_add_f32 v17, v17, v113
    v_add_f32 v18, v18, v114
    v_add_f32 v19, v19, v115
    v_add_f32 v20, v20, v116
    v_add_f32 v21, v21, v117
    v_add_f32 v22, v22, v118
    v_add_f32 v23, v23, v119
    v_add_f32 v24, v24, v120
    v_add_f32 v25, v25, v121
    v_add_f32 v26, v26, v122
    v_add_f32 v27, v27, v123
    v_add_f32 v28, v28, v124
    v_add_f32 v29, v29, v125
    v_add_f32 v30, v30, v126
    v_add_f32 v31, v31, v127
    s_and_b32 s63, s62, 0xffff
    s_sub_u32 s63, 2047, s63
    s_lshr_b32 s64, s63, 5
    s_cmp_lg_u32 s64, s54
    s_cbranch_scc1 L_35
    v_lshlrev_b32 v13, 4, v0
    v_add_u32 v13, 282624, v13
    buffer_load_dwordx4 v[64:67], v13, s[12:15], 0 offen sc1
    s_waitcnt vmcnt(0)
    s_mov_b32 s3, 300000
L_spin_36:
    v_xor_b32 v64, s23, v64
    v_xor_b32 v65, s23, v65
    v_or_b32 v64, v64, v65
    v_xor_b32 v66, s23, v66
    v_or_b32 v64, v64, v66
    v_xor_b32 v67, s23, v67
    v_or_b32 v64, v64, v67
    v_cmp_ne_u32 vcc, 0, v64
    s_nop 1
    s_cmp_eq_u64 vcc, 0
    s_cbranch_scc1 L_ok_37
    buffer_load_dwordx4 v[64:67], v13, s[12:15], 0 offen sc1
    s_waitcnt vmcnt(0)
    s_sub_u32 s3, s3, 1
    s_cmp_lg_u32 s3, 0
    s_cbranch_scc1 L_spin_36
    s_endpgm
L_ok_37:
    v_lshrrev_b32 v4, 3, v0
    v_and_b32 v5, 7, v0
    v_lshlrev_b32 v5, 4, v5
    v_lshl_add_u32 v4, v4, 12, v5
    s_lshl_b32 s64, s56, 1
    s_add_u32 s64, s64, 229376
    buffer_load_dwordx4 v[64:67], v4, s[12:15], s64 offen sc1
    s_and_b32 s65, s62, 0xffff0000
    s_ashr_i32 s66, s65, 31
    s_not_b32 s66, s66
    s_or_b32 s66, s66, 0x80000000
    s_xor_b32 s65, s65, s66
    s_and_b32 s65, s65, 0xffff0000
    v_mov_b32 v68, s65
    v_mul_f32 v68, 0xbfb8aa3b, v68
    v_exp_f32 v68, v68
    s_nop 0
    v_add_f32 v68, 1.0, v68
    v_rcp_f32 v68, v68
    s_nop 0
    v_cvt_pk_bf16_f32 v68, v68, v68
    v_and_b32 v68, 0xffff0000, v68
    s_waitcnt vmcnt(0)
    v_add_f32_dpp v64, v64, v64 row_ror:8
    v_add_f32_dpp v65, v65, v65 row_ror:8
    v_add_f32_dpp v66, v66, v66 row_ror:8
    v_add_f32_dpp v67, v67, v67 row_ror:8
    v_mov_b32 v72, v64
    v_mov_b32 v73, v65
    v_mov_b32 v74, v66
    v_mov_b32 v75, v67
    s_nop 1
    v_permlane16_swap_b32 v64, v72
    v_permlane16_swap_b32 v65, v73
    v_permlane16_swap_b32 v66, v74
    v_permlane16_swap_b32 v67, v75
    v_add_f32 v64, v64, v72
    v_add_f32 v65, v65, v73
    v_add_f32 v66, v66, v74
    v_add_f32 v67, v67, v75
    v_mov_b32 v72, v64
    v_mov_b32 v73, v65
    v_mov_b32 v74, v66
    v_mov_b32 v75, v67
    s_nop 1
    v_permlane32_swap_b32 v64, v72
    v_permlane32_swap_b32 v65, v73
    v_permlane32_swap_b32 v66, v74
    v_permlane32_swap_b32 v67, v75
    v_add_f32 v64, v64, v72
    v_add_f32 v65, v65, v73
    v_add_f32 v66, v66, v74
    v_add_f32 v67, v67, v75
    v_cvt_pk_bf16_f32 v64, v64, v64
    v_and_b32 v64, 0xffff0000, v64
    v_mul_f32 v64, v64, v68
    v_cvt_pk_bf16_f32 v64, v64, v64
    v_and_b32 v64, 0xffff0000, v64
    v_cvt_pk_bf16_f32 v65, v65, v65
    v_and_b32 v65, 0xffff0000, v65
    v_mul_f32 v65, v65, v68
    v_cvt_pk_bf16_f32 v65, v65, v65
    v_and_b32 v65, 0xffff0000, v65
    v_cvt_pk_bf16_f32 v66, v66, v66
    v_and_b32 v66, 0xffff0000, v66
    v_mul_f32 v66, v66, v68
    v_cvt_pk_bf16_f32 v66, v66, v66
    v_and_b32 v66, 0xffff0000, v66
    v_cvt_pk_bf16_f32 v67, v67, v67
    v_and_b32 v67, 0xffff0000, v67
    v_mul_f32 v67, v67, v68
    v_cvt_pk_bf16_f32 v67, v67, v67
    v_and_b32 v67, 0xffff0000, v67
    v_lshrrev_b32 v4, 5, v0
    v_lshlrev_b32 v4, 4, v4
    s_and_b32 s64, s63, 31
    v_and_b32 v5, 31, v0
    v_cmp_eq_u32 vcc, s64, v5
    v_add_u32 v5, 0, v4
    ds_bpermute_b32 v72, v5, v64
    ds_bpermute_b32 v73, v5, v65
    ds_bpermute_b32 v74, v5, v66
    ds_bpermute_b32 v75, v5, v67
    s_waitcnt lgkmcnt(0)
    v_add_f32 v72, v72, v112
    v_cvt_pk_bf16_f32 v72, v72, v72
    v_and_b32 v72, 0xffff0000, v72
    v_sub_f32 v72, v72, v112
    v_add_f32 v72, v72, v16
    v_cndmask_b32 v16, v16, v72, vcc
    v_add_f32 v73, v73, v113
    v_cvt_pk_bf16_f32 v73, v73, v73
    v_and_b32 v73, 0xffff0000, v73
    v_sub_f32 v73, v73, v113
    v_add_f32 v73, v73, v17
    v_cndmask_b32 v17, v17, v73, vcc
    v_add_f32 v74, v74, v114
    v_cvt_pk_bf16_f32 v74, v74, v74
    v_and_b32 v74, 0xffff0000, v74
    v_sub_f32 v74, v74, v114
    v_add_f32 v74, v74, v18
    v_cndmask_b32 v18, v18, v74, vcc
    v_add_f32 v75, v75, v115
    v_cvt_pk_bf16_f32 v75, v75, v75
    v_and_b32 v75, 0xffff0000, v75
    v_sub_f32 v75, v75, v115
    v_add_f32 v75, v75, v19
    v_cndmask_b32 v19, v19, v75, vcc
    v_add_u32 v5, 4, v4
    ds_bpermute_b32 v72, v5, v64
    ds_bpermute_b32 v73, v5, v65
    ds_bpermute_b32 v74, v5, v66
    ds_bpermute_b32 v75, v5, v67
    s_waitcnt lgkmcnt(0)
    v_add_f32 v72, v72, v116
    v_cvt_pk_bf16_f32 v72, v72, v72
    v_and_b32 v72, 0xffff0000, v72
    v_sub_f32 v72, v72, v116
    v_add_f32 v72, v72, v20
    v_cndmask_b32 v20, v20, v72, vcc
    v_add_f32 v73, v73, v117
    v_cvt_pk_bf16_f32 v73, v73, v73
    v_and_b32 v73, 0xffff0000, v73
    v_sub_f32 v73, v73, v117
    v_add_f32 v73, v73, v21
    v_cndmask_b32 v21, v21, v73, vcc
    v_add_f32 v74, v74, v118
    v_cvt_pk_bf16_f32 v74, v74, v74
    v_and_b32 v74, 0xffff0000, v74
    v_sub_f32 v74, v74, v118
    v_add_f32 v74, v74, v22
    v_cndmask_b32 v22, v22, v74, vcc
    v_add_f32 v75, v75, v119
    v_cvt_pk_bf16_f32 v75, v75, v75
    v_and_b32 v75, 0xffff0000, v75
    v_sub_f32 v75, v75, v119
    v_add_f32 v75, v75, v23
    v_cndmask_b32 v23, v23, v75, vcc
    v_add_u32 v5, 8, v4
    ds_bpermute_b32 v72, v5, v64
    ds_bpermute_b32 v73, v5, v65
    ds_bpermute_b32 v74, v5, v66
    ds_bpermute_b32 v75, v5, v67
    s_waitcnt lgkmcnt(0)
    v_add_f32 v72, v72, v120
    v_cvt_pk_bf16_f32 v72, v72, v72
    v_and_b32 v72, 0xffff0000, v72
    v_sub_f32 v72, v72, v120
    v_add_f32 v72, v72, v24
    v_cndmask_b32 v24, v24, v72, vcc
    v_add_f32 v73, v73, v121
    v_cvt_pk_bf16_f32 v73, v73, v73
    v_and_b32 v73, 0xffff0000, v73
    v_sub_f32 v73, v73, v121
    v_add_f32 v73, v73, v25
    v_cndmask_b32 v25, v25, v73, vcc
    v_add_f32 v74, v74, v122
    v_cvt_pk_bf16_f32 v74, v74, v74
    v_and_b32 v74, 0xffff0000, v74
    v_sub_f32 v74, v74, v122
    v_add_f32 v74, v74, v26
    v_cndmask_b32 v26, v26, v74, vcc
    v_add_f32 v75, v75, v123
    v_cvt_pk_bf16_f32 v75, v75, v75
    v_and_b32 v75, 0xffff0000, v75
    v_sub_f32 v75, v75, v123
    v_add_f32 v75, v75, v27
    v_cndmask_b32 v27, v27, v75, vcc
    v_add_u32 v5, 12, v4
    ds_bpermute_b32 v72, v5, v64
    ds_bpermute_b32 v73, v5, v65
    ds_bpermute_b32 v74, v5, v66
    ds_bpermute_b32 v75, v5, v67
    s_waitcnt lgkmcnt(0)
    v_add_f32 v72, v72, v124
    v_cvt_pk_bf16_f32 v72, v72, v72
    v_and_b32 v72, 0xffff0000, v72
    v_sub_f32 v72, v72, v124
    v_add_f32 v72, v72, v28
    v_cndmask_b32 v28, v28, v72, vcc
    v_add_f32 v73, v73, v125
    v_cvt_pk_bf16_f32 v73, v73, v73
    v_and_b32 v73, 0xffff0000, v73
    v_sub_f32 v73, v73, v125
    v_add_f32 v73, v73, v29
    v_cndmask_b32 v29, v29, v73, vcc
    v_add_f32 v74, v74, v126
    v_cvt_pk_bf16_f32 v74, v74, v74
    v_and_b32 v74, 0xffff0000, v74
    v_sub_f32 v74, v74, v126
    v_add_f32 v74, v74, v30
    v_cndmask_b32 v30, v30, v74, vcc
    v_add_f32 v75, v75, v127
    v_cvt_pk_bf16_f32 v75, v75, v75
    v_and_b32 v75, 0xffff0000, v75
    v_sub_f32 v75, v75, v127
    v_add_f32 v75, v75, v31
    v_cndmask_b32 v31, v31, v75, vcc
L_35:
    s_branch L_34
L_33:
    s_lshr_b32 s28, s38, 2
    s_lshl_b32 s28, s28, 7
    s_add_u32 s28, s28, 458752
    v_and_b32 v12, 31, v0
    v_lshlrev_b32 v12, 2, v12
    buffer_load_dword v7, v12, s[12:15], s28 offen sc1
    s_waitcnt vmcnt(0)
    s_mov_b32 s3, 300000
L_spin_38:
    v_cmp_ne_u32 vcc, s23, v7
    s_nop 1
    s_cmp_eq_u64 vcc, 0
    s_cbranch_scc1 L_ok_39
    buffer_load_dword v7, v12, s[12:15], s28 offen sc1
    s_waitcnt vmcnt(0)
    s_sub_u32 s3, s3, 1
    s_cmp_lg_u32 s3, 0
    s_cbranch_scc1 L_spin_38
    s_endpgm
L_ok_39:
L_34:
    s_and_b32 s59, s20, 1
    s_lshl_b32 s59, s59, 16
    s_bfe_u32 s60, s20, 0x10001
    s_lshl_b32 s60, s60, 15
    s_add_u32 s59, s59, s60
    s_lshr_b32 s61, s20, 2
    s_waitcnt lgkmcnt(0)
    s_barrier
L_panel:
    s_mul_i32 s60, s61, 2048
    s_add_u32 s60, s60, s59
    s_add_u32 m0, s60, 0
    s_add_u32 s60, m0, s58
    buffer_load_dwordx4 v2, s[12:15], s60 offen offset:0 sc1 lds
    buffer_load_dwordx4 v2, s[12:15], s60 offen offset:1024 sc1 lds
    s_mul_i32 s60, s61, 2048
    s_add_u32 s60, s60, s59
    s_add_u32 m0, s60, 4096
    s_add_u32 s60, m0, s58
    buffer_load_dwordx4 v2, s[12:15], s60 offen offset:0 sc1 lds
    buffer_load_dwordx4 v2, s[12:15], s60 offen offset:1024 sc1 lds
    s_cmp_eq_u32 s20, s37
    s_cbranch_scc0 L_40
    s_mov_b32 s37, -1
    v_lshlrev_b32 v16, 16, v104
    v_and_b32 v17, 0xffff0000, v104
    v_lshlrev_b32 v18, 16, v105
    v_and_b32 v19, 0xffff0000, v105
    v_lshlrev_b32 v20, 16, v106
    v_and_b32 v21, 0xffff0000, v106
    v_lshlrev_b32 v22, 16, v107
    v_and_b32 v23, 0xffff0000, v107
    v_lshlrev_b32 v24, 16, v108
    v_and_b32 v25, 0xffff0000, v108
    v_lshlrev_b32 v26, 16, v109
    v_and_b32 v27, 0xffff0000, v109
    v_lshlrev_b32 v28, 16, v110
    v_and_b32 v29, 0xffff0000, v110
    v_lshlrev_b32 v30, 16, v111
    v_and_b32 v31, 0xffff0000, v111
    v_sub_f32 v4, v16, v8
    v_sub_f32 v5, v17, v8
    v_cvt_pk_bf16_f32 v4, v4, v5
    v_and_b32 v5, 0xffff0000, v4
    v_lshlrev_b32 v4, 16, v4
    v_mul_f32 v4, v4, v9
    v_mul_f32 v5, v5, v9
    v_cvt_pk_bf16_f32 v4, v4, v5
    v_and_b32 v113, 0xffff0000, v4
    v_lshlrev_b32 v112, 16, v4
    v_sub_f32 v4, v18, v8
    v_sub_f32 v5, v19, v8
    v_cvt_pk_bf16_f32 v4, v4, v5
    v_and_b32 v5, 0xffff0000, v4
    v_lshlrev_b32 v4, 16, v4
    v_mul_f32 v4, v4, v9
    v_mul_f32 v5, v5, v9
    v_cvt_pk_bf16_f32 v4, v4, v5
    v_and_b32 v115, 0xffff0000, v4
    v_lshlrev_b32 v114, 16, v4
    v_sub_f32 v4, v20, v8
    v_sub_f32 v5, v21, v8
    v_cvt_pk_bf16_f32 v4, v4, v5
    v_and_b32 v5, 0xffff0000, v4
    v_lshlrev_b32 v4, 16, v4
    v_mul_f32 v4, v4, v9
    v_mul_f32 v5, v5, v9
    v_cvt_pk_bf16_f32 v4, v4, v5
    v_and_b32 v117, 0xffff0000, v4
    v_lshlrev_b32 v116, 16, v4
    v_sub_f32 v4, v22, v8
    v_sub_f32 v5, v23, v8
    v_cvt_pk_bf16_f32 v4, v4, v5
    v_and_b32 v5, 0xffff0000, v4
    v_lshlrev_b32 v4, 16, v4
    v_mul_f32 v4, v4, v9
    v_mul_f32 v5, v5, v9
    v_cvt_pk_bf16_f32 v4, v4, v5
    v_and_b32 v119, 0xffff0000, v4
    v_lshlrev_b32 v118, 16, v4
    v_sub_f32 v4, v24, v8
    v_sub_f32 v5, v25, v8
    v_cvt_pk_bf16_f32 v4, v4, v5
    v_and_b32 v5, 0xffff0000, v4
    v_lshlrev_b32 v4, 16, v4
    v_mul_f32 v4, v4, v9
    v_mul_f32 v5, v5, v9
    v_cvt_pk_bf16_f32 v4, v4, v5
    v_and_b32 v121, 0xffff0000, v4
    v_lshlrev_b32 v120, 16, v4
    v_sub_f32 v4, v26, v8
    v_sub_f32 v5, v27, v8
    v_cvt_pk_bf16_f32 v4, v4, v5
    v_and_b32 v5, 0xffff0000, v4
    v_lshlrev_b32 v4, 16, v4
    v_mul_f32 v4, v4, v9
    v_mul_f32 v5, v5, v9
    v_cvt_pk_bf16_f32 v4, v4, v5
    v_and_b32 v123, 0xffff0000, v4
    v_lshlrev_b32 v122, 16, v4
    v_sub_f32 v4, v28, v8
    v_sub_f32 v5, v29, v8
    v_cvt_pk_bf16_f32 v4, v4, v5
    v_and_b32 v5, 0xffff0000, v4
    v_lshlrev_b32 v4, 16, v4
    v_mul_f32 v4, v4, v9
    v_mul_f32 v5, v5, v9
    v_cvt_pk_bf16_f32 v4, v4, v5
    v_and_b32 v125, 0xffff0000, v4
    v_lshlrev_b32 v124, 16, v4
    v_sub_f32 v4, v30, v8
    v_sub_f32 v5, v31, v8
    v_cvt_pk_bf16_f32 v4, v4, v5
    v_and_b32 v5, 0xffff0000, v4
    v_lshlrev_b32 v4, 16, v4
    v_mul_f32 v4, v4, v9
    v_mul_f32 v5, v5, v9
    v_cvt_pk_bf16_f32 v4, v4, v5
    v_and_b32 v127, 0xffff0000, v4
    v_lshlrev_b32 v126, 16, v4
    v_add_f32 v16, v16, v112
    v_add_f32 v17, v17, v113
    v_add_f32 v18, v18, v114
    v_add_f32 v19, v19, v115
    v_add_f32 v20, v20, v116
    v_add_f32 v21, v21, v117
    v_add_f32 v22, v22, v118
    v_add_f32 v23, v23, v119
    v_add_f32 v24, v24, v120
    v_add_f32 v25, v25, v121
    v_add_f32 v26, v26, v122
    v_add_f32 v27, v27, v123
    v_add_f32 v28, v28, v124
    v_add_f32 v29, v29, v125
    v_add_f32 v30, v30, v126
    v_add_f32 v31, v31, v127
L_40:
    s_lshr_b32 s53, s20, 2
    s_mul_i32 s53, s53, 0x18000
    v_add_u32 v8, s53, v2
    v_xor_b32 v9, 65536, v8
    s_lshl_b32 s27, s20, 11
    v_and_b32 v4, 31, v0
    v_lshrrev_b32 v5, 5, v0
    v_lshlrev_b32 v5, 1, v5
    v_bfe_u32 v6, v0, 1, 2
    v_xor_b32 v5, v5, v6
    v_lshlrev_b32 v5, 4, v5
    v_lshl_add_u32 v10, v4, 6, v5
    v_add_u32 v10, s27, v10
    v_xor_b32 v11, 16, v10
    v_lshrrev_b32 v4, 2, v0
    v_and_b32 v5, 3, v0
    v_bfe_u32 v6, v0, 3, 2
    v_xor_b32 v6, v6, v5
    v_lshlrev_b32 v6, 4, v6
    v_lshl_add_u32 v12, v4, 6, v6
    v_add_u32 v12, s27, v12
    s_lshl_b32 s27, s54, 5
    v_add_u32 v4, s27, v4
    v_lshlrev_b32 v4, 11, v4
    v_lshl_add_u32 v14, v5, 4, v4
    v_add_u32 v14, s56, v14
    s_mov_b32 s27, 32768
    s_waitcnt vmcnt(2)
    s_barrier
    ds_read_b128 v[64:67], v8 offset:0
    ds_read_b128 v[68:71], v9 offset:0
    ds_read_b128 v[72:75], v8 offset:1024
    ds_read_b128 v[76:79], v9 offset:1024
    ds_read_b128 v[80:83], v8 offset:2048
    ds_read_b128 v[84:87], v9 offset:2048
    ds_read_b128 v[88:91], v8 offset:3072
    ds_read_b128 v[92:95], v9 offset:3072
    s_waitcnt lgkmcnt(6)
    v_mfma_f32_32x32x16_bf16 v[32:47], a[0:3], v[64:67], 0
    s_mul_i32 s60, s61, 2048
    s_add_u32 s60, s60, s59
    s_add_u32 m0, s60, 8192
    s_add_u32 s60, m0, s58
    buffer_load_dwordx4 v2, s[12:15], s60 offen offset:0 sc1 lds
    v_mfma_f32_32x32x16_bf16 v[48:63], a[0:3], v[68:71], 0
    s_waitcnt vmcnt(1)
    s_barrier
    ds_read_b128 v[64:67], v8 offset:4096
    ds_read_b128 v[68:71], v9 offset:4096
    s_waitcnt lgkmcnt(6)
    v_mfma_f32_32x32x16_bf16 v[32:47], a[4:7], v[72:75], v[32:47]
    buffer_load_dwordx4 v2, s[12:15], s60 offen offset:1024 sc1 lds
    v_mfma_f32_32x32x16_bf16 v[48:63], a[4:7], v[76:79], v[48:63]
    ds_read_b128 v[72:75], v8 offset:5120
    ds_read_b128 v[76:79], v9 offset:5120
    s_waitcnt lgkmcnt(6)
    v_mfma_f32_32x32x16_bf16 v[32:47], a[8:11], v[80:83], v[32:47]
    s_mul_i32 s60, s61, 2048
    s_add_u32 s60, s60, s59
    s_add_u32 m0, s60, 12288
    s_add_u32 s60, m0, s58
    buffer_load_dwordx4 v2, s[12:15], s60 offen offset:0 sc1 lds
    v_mfma_f32_32x32x16_bf16 v[48:63], a[8:11], v[84:87], v[48:63]
    ds_read_b128 v[80:83], v8 offset:6144
    ds_read_b128 v[84:87], v9 offset:6144
    s_waitcnt lgkmcnt(6)
    v_mfma_f32_32x32x16_bf16 v[32:47], a[12:15], v[88:91], v[32:47]
    buffer_load_dwordx4 v2, s[12:15], s60 offen offset:1024 sc1 lds
    v_mfma_f32_32x32x16_bf16 v[48:63], a[12:15], v[92:95], v[48:63]
    ds_read_b128 v[88:91], v8 offset:7168
    ds_read_b128 v[92:95], v9 offset:7168
    s_waitcnt lgkmcnt(6)
    v_mfma_f32_32x32x16_bf16 v[32:47], a[16:19], v[64:67], v[32:47]
    s_mul_i32 s60, s61, 2048
    s_add_u32 s60, s60, s59
    s_add_u32 m0, s60, 16384
    s_add_u32 s60, m0, s58
    buffer_load_dwordx4 v2, s[12:15], s60 offen offset:0 sc1 lds
    v_mfma_f32_32x32x16_bf16 v[48:63], a[16:19], v[68:71], v[48:63]
    s_waitcnt vmcnt(3)
    s_barrier
    ds_read_b128 v[64:67], v8 offset:8192
    ds_read_b128 v[68:71], v9 offset:8192
    s_waitcnt lgkmcnt(6)
    v_mfma_f32_32x32x16_bf16 v[32:47], a[20:23], v[72:75], v[32:47]
    buffer_load_dwordx4 v2, s[12:15], s60 offen offset:1024 sc1 lds
    v_mfma_f32_32x32x16_bf16 v[48:63], a[20:23], v[76:79], v[48:63]
    ds_read_b128 v[72:75], v8 offset:9216
    ds_read_b128 v[76:79], v9 offset:9216
    s_waitcnt lgkmcnt(6)
    v_mfma_f32_32x32x16_bf16 v[32:47], a[24:27], v[80:83], v[32:47]
    s_mul_i32 s60, s61, 2048
    s_add_u32 s60, s60, s59
    s_add_u32 m0, s60, 20480
    s_add_u32 s60, m0, s58
    buffer_load_dwordx4 v2, s[12:15], s60 offen offset:0 sc1 lds
    v_mfma_f32_32x32x16_bf16 v[48:63], a[24:27], v[84:87], v[48:63]
    ds_read_b128 v[80:83], v8 offset:10240
    ds_read_b128 v[84:87], v9 offset:10240
    s_waitcnt lgkmcnt(6)
    v_mfma_f32_32x32x16_bf16 v[32:47], a[28:31], v[88:91], v[32:47]
    buffer_load_dwordx4 v2, s[12:15], s60 offen offset:1024 sc1 lds
    v_mfma_f32_32x32x16_bf16 v[48:63], a[28:31], v[92:95], v[48:63]
    ds_read_b128 v[88:91], v8 offset:11264
    ds_read_b128 v[92:95], v9 offset:11264
    s_waitcnt lgkmcnt(6)
    v_mfma_f32_32x32x16_bf16 v[32:47], a[32:35], v[64:67], v[32:47]
    s_mul_i32 s60, s61, 4096
    s_add_u32 s60, s60, s59
    s_add_u32 m0, s60, 24576
    s_add_u32 s60, m0, s58
    buffer_load_dwordx4 v2, s[12:15], s60 offen offset:0 sc1 lds
    v_mfma_f32_32x32x16_bf16 v[48:63], a[32:35], v[68:71], v[48:63]
    s_waitcnt vmcnt(5)
    s_barrier
    ds_read_b128 v[64:67], v8 offset:12288
    ds_read_b128 v[68:71], v9 offset:12288
    s_waitcnt lgkmcnt(6)
    v_mfma_f32_32x32x16_bf16 v[32:47], a[36:39], v[72:75], v[32:47]
    buffer_load_dwordx4 v2, s[12:15], s60 offen offset:1024 sc1 lds
    v_mfma_f32_32x32x16_bf16 v[48:63], a[36:39], v[76:79], v[48:63]
    ds_read_b128 v[72:75], v8 offset:13312
    ds_read_b128 v[76:79], v9 offset:13312
    s_waitcnt lgkmcnt(6)
    v_mfma_f32_32x32x16_bf16 v[32:47], a[40:43], v[80:83], v[32:47]
    buffer_load_dwordx4 v2, s[12:15], s60 offen offset:2048 sc1 lds
    v_mfma_f32_32x32x16_bf16 v[48:63], a[40:43], v[84:87], v[48:63]
    ds_read_b128 v[80:83], v8 offset:14336
    ds_read_b128 v[84:87], v9 offset:14336
    s_waitcnt lgkmcnt(6)
    v_mfma_f32_32x32x16_bf16 v[32:47], a[44:47], v[88:91], v[32:47]
    buffer_load_dwordx4 v2, s[12:15], s60 offen offset:3072 sc1 lds
    v_mfma_f32_32x32x16_bf16 v[48:63], a[44:47], v[92:95], v[48:63]
    ds_read_b128 v[88:91], v8 offset:15360
    ds_read_b128 v[92:95], v9 offset:15360
    s_waitcnt lgkmcnt(6)
    v_mfma_f32_32x32x16_bf16 v[32:47], a[48:51], v[64:67], v[32:47]
    v_mfma_f32_32x32x16_bf16 v[48:63], a[48:51], v[68:71], v[48:63]
    s_waitcnt vmcnt(6)
    s_barrier
    ds_read_b128 v[64:67], v8 offset:16384
    ds_read_b128 v[68:71], v9 offset:16384
    s_waitcnt lgkmcnt(6)
    v_mfma_f32_32x32x16_bf16 v[32:47], a[52:55], v[72:75], v[32:47]
    v_mfma_f32_32x32x16_bf16 v[48:63], a[52:55], v[76:79], v[48:63]
    ds_read_b128 v[72:75], v8 offset:17408
    ds_read_b128 v[76:79], v9 offset:17408
    s_waitcnt lgkmcnt(6)
    v_mfma_f32_32x32x16_bf16 v[32:47], a[56:59], v[80:83], v[32:47]
    v_mfma_f32_32x32x16_bf16 v[48:63], a[56:59], v[84:87], v[48:63]
    ds_read_b128 v[80:83], v8 offset:18432
    ds_read_b128 v[84:87], v9 offset:18432
    s_waitcnt lgkmcnt(6)
    v_mfma_f32_32x32x16_bf16 v[32:47], a[60:63], v[88:91], v[32:47]
    v_mfma_f32_32x32x16_bf16 v[48:63], a[60:63], v[92:95], v[48:63]
    ds_read_b128 v[88:91], v8 offset:19456
    ds_read_b128 v[92:95], v9 offset:19456
    s_waitcnt lgkmcnt(6)
    v_mfma_f32_32x32x16_bf16 v[32:47], a[64:67], v[64:67], v[32:47]
    v_mfma_f32_32x32x16_bf16 v[48:63], a[64:67], v[68:71], v[48:63]
    s_waitcnt vmcnt(4)
    s_barrier
    ds_read_b128 v[64:67], v8 offset:20480
    ds_read_b128 v[68:71], v9 offset:20480
    s_waitcnt lgkmcnt(6)
    v_mfma_f32_32x32x16_bf16 v[32:47], a[68:71], v[72:75], v[32:47]
    v_mfma_f32_32x32x16_bf16 v[48:63], a[68:71], v[76:79], v[48:63]
    ds_read_b128 v[72:75], v8 offset:21504
    ds_read_b128 v[76:79], v9 offset:21504
    s_waitcnt lgkmcnt(6)
    v_mfma_f32_32x32x16_bf16 v[32:47], a[72:75], v[80:83], v[32:47]
    v_mfma_f32_32x32x16_bf16 v[48:63], a[72:75], v[84:87], v[48:63]
    ds_read_b128 v[80:83], v8 offset:22528
    ds_read_b128 v[84:87], v9 offset:22528
    s_waitcnt lgkmcnt(6)
    v_mfma_f32_32x32x16_bf16 v[32:47], a[76:79], v[88:91], v[32:47]
    v_mfma_f32_32x32x16_bf16 v[48:63], a[76:79], v[92:95], v[48:63]
    ds_read_b128 v[88:91], v8 offset:23552
    ds_read_b128 v[92:95], v9 offset:23552
    s_waitcnt lgkmcnt(6)
    v_mfma_f32_32x32x16_bf16 v[32:47], a[80:83], v[64:67], v[32:47]
    v_mfma_f32_32x32x16_bf16 v[48:63], a[80:83], v[68:71], v[48:63]
    s_waitcnt vmcnt(0)
    s_barrier
    ds_read_b128 v[64:67], v8 offset:24576
    ds_read_b128 v[68:71], v9 offset:24576
    s_waitcnt lgkmcnt(6)
    v_mfma_f32_32x32x16_bf16 v[32:47], a[84:87], v[72:75], v[32:47]
    v_mfma_f32_32x32x16_bf16 v[48:63], a[84:87], v[76:79], v[48:63]
    ds_read_b128 v[72:75], v8 offset:25600
    ds_read_b128 v[76:79], v9 offset:25600
    s_waitcnt lgkmcnt(6)
    v_mfma_f32_32x32x16_bf16 v[32:47], a[88:91], v[80:83], v[32:47]
    v_mfma_f32_32x32x16_bf16 v[48:63], a[88:91], v[84:87], v[48:63]
    ds_read_b128 v[80:83], v8 offset:26624
    ds_read_b128 v[84:87], v9 offset:26624
    s_waitcnt lgkmcnt(6)
    v_mfma_f32_32x32x16_bf16 v[32:47], a[92:95], v[88:91], v[32:47]
    v_mfma_f32_32x32x16_bf16 v[48:63], a[92:95], v[92:95], v[48:63]
    ds_read_b128 v[88:91], v8 offset:27648
    ds_read_b128 v[92:95], v9 offset:27648
    s_waitcnt lgkmcnt(6)
    v_mfma_f32_32x32x16_bf16 v[32:47], a[96:99], v[64:67], v[32:47]
    v_mfma_f32_32x32x16_bf16 v[48:63], a[96:99], v[68:71], v[48:63]
    ds_read_b128 v[64:67], v8 offset:28672
    ds_read_b128 v[68:71], v9 offset:28672
    s_waitcnt lgkmcnt(6)
    v_mfma_f32_32x32x16_bf16 v[32:47], a[100:103], v[72:75], v[32:47]
    v_mfma_f32_32x32x16_bf16 v[48:63], a[100:103], v[76:79], v[48:63]
    ds_read_b128 v[72:75], v8 offset:29696
    ds_read_b128 v[76:79], v9 offset:29696
    s_waitcnt lgkmcnt(6)
    v_mfma_f32_32x32x16_bf16 v[32:47], a[104:107], v[80:83], v[32:47]
    v_mfma_f32_32x32x16_bf16 v[48:63], a[104:107], v[84:87], v[48:63]
    ds_read_b128 v[80:83], v8 offset:30720
    ds_read_b128 v[84:87], v9 offset:30720
    s_waitcnt lgkmcnt(6)
    v_mfma_f32_32x32x16_bf16 v[32:47], a[108:111], v[88:91], v[32:47]
    v_mfma_f32_32x32x16_bf16 v[48:63], a[108:111], v[92:95], v[48:63]
    ds_read_b128 v[88:91], v8 offset:31744
    ds_read_b128 v[92:95], v9 offset:31744
    s_waitcnt lgkmcnt(6)
    v_mfma_f32_32x32x16_bf16 v[32:47], a[112:115], v[64:67], v[32:47]
    v_mfma_f32_32x32x16_bf16 v[48:63], a[112:115], v[68:71], v[48:63]
    s_waitcnt lgkmcnt(4)
    v_mfma_f32_32x32x16_bf16 v[32:47], a[116:119], v[72:75], v[32:47]
    v_mfma_f32_32x32x16_bf16 v[48:63], a[116:119], v[76:79], v[48:63]
    s_waitcnt lgkmcnt(2)
    v_mfma_f32_32x32x16_bf16 v[32:47], a[120:123], v[80:83], v[32:47]
    v_mfma_f32_32x32x16_bf16 v[48:63], a[120:123], v[84:87], v[48:63]
    s_waitcnt lgkmcnt(0)
    v_mfma_f32_32x32x16_bf16 v[32:47], a[124:127], v[88:91], v[32:47]
    v_mfma_f32_32x32x16_bf16 v[48:63], a[124:127], v[92:95], v[48:63]
    s_lshl_b32 s53, s20, 12
    s_add_u32 s53, s53, 131072
    v_add_u32 v8, s53, v2
    v_xor_b32 v9, 16384, v8
    s_nop 8
    ds_write_b128 v8, v[48:51] offset:0
    ds_write_b128 v8, v[52:55] offset:1024
    ds_write_b128 v8, v[56:59] offset:2048
    ds_write_b128 v8, v[60:63] offset:3072
    s_waitcnt lgkmcnt(0)
    s_barrier
    ds_read_b128 v[48:51], v9 offset:0
    ds_read_b128 v[52:55], v9 offset:1024
    ds_read_b128 v[56:59], v9 offset:2048
    ds_read_b128 v[60:63], v9 offset:3072
    v_pk_add_f32 v[32:33], v[32:33], v[16:17]
    v_pk_add_f32 v[34:35], v[34:35], v[18:19]
    v_pk_add_f32 v[36:37], v[36:37], v[20:21]
    v_pk_add_f32 v[38:39], v[38:39], v[22:23]
    v_pk_add_f32 v[40:41], v[40:41], v[24:25]
    v_pk_add_f32 v[42:43], v[42:43], v[26:27]
    v_pk_add_f32 v[44:45], v[44:45], v[28:29]
    v_pk_add_f32 v[46:47], v[46:47], v[30:31]
    s_waitcnt lgkmcnt(0)
    v_pk_add_f32 v[32:33], v[32:33], v[48:49]
    v_pk_add_f32 v[34:35], v[34:35], v[50:51]
    v_pk_add_f32 v[36:37], v[36:37], v[52:53]
    v_pk_add_f32 v[38:39], v[38:39], v[54:55]
    v_pk_add_f32 v[40:41], v[40:41], v[56:57]
    v_pk_add_f32 v[42:43], v[42:43], v[58:59]
    v_pk_add_f32 v[44:45], v[44:45], v[60:61]
    v_pk_add_f32 v[46:47], v[46:47], v[62:63]
    v_cvt_pk_bf16_f32 v32, v32, v33
    v_cvt_pk_bf16_f32 v33, v34, v35
    v_cvt_pk_bf16_f32 v34, v36, v37
    v_cvt_pk_bf16_f32 v35, v38, v39
    v_cvt_pk_bf16_f32 v36, v40, v41
    v_cvt_pk_bf16_f32 v37, v42, v43
    v_cvt_pk_bf16_f32 v38, v44, v45
    v_cvt_pk_bf16_f32 v39, v46, v47
    ds_write_b128 v10, v[32:35]
    ds_write_b128 v11, v[36:39]
    s_waitcnt lgkmcnt(0)
    ds_read_b128 v[48:51], v12
    ds_read_b128 v[52:55], v12 offset:1024
    s_waitcnt lgkmcnt(1)
    buffer_store_dwordx4 v[48:51], v14, s[16:19], 0 offen nt
    s_waitcnt lgkmcnt(0)
    buffer_store_dwordx4 v[52:55], v14, s[16:19], s27 offen nt
L_exit_f:
    s_endpgm
L_code1:
L_safe:
    s_waitcnt vmcnt(0)
    v_mov_b32 v64, 0
    v_mov_b32 v65, 0
    v_mov_b32 v66, 0
    v_mov_b32 v67, 0
    v_mov_b32 v68, 0
    v_mov_b32 v69, 0
    v_mov_b32 v70, 0
    v_mov_b32 v71, 0
    v_mov_b32 v72, 0
    v_mov_b32 v73, 0
    v_mov_b32 v74, 0
    v_mov_b32 v75, 0
    v_mov_b32 v76, 0
    v_mov_b32 v77, 0
    v_mov_b32 v78, 0
    v_mov_b32 v79, 0
    v_mov_b32 v24, 0
    v_mov_b32 v25, 0
    v_mov_b32 v26, 0
    v_mov_b32 v27, 0
    v_mov_b32 v8, 0xff7fffff
    s_lshl_b32 s30, s21, 19
    s_and_b32 s33, s22, 1
    s_lshl_b32 s33, s33, 14
    s_add_u32 s30, s30, s33
    s_lshl_b32 s33, s20, 11
    s_add_u32 s30, s30, s33
    s_add_u32 s30, s30, 1048576
    s_mov_b32 s35, 0
L_safe_41:
    s_barrier
    s_mov_b32 m0, s33
    s_nop 0
    buffer_load_dwordx4 v2, s[12:15], s30 offen offset:0 sc1 lds
    buffer_load_dwordx4 v2, s[12:15], s30 offen offset:1024 sc1 lds
    s_add_u32 s30, s30, 32768
    s_waitcnt vmcnt(0)
    s_barrier
    v_mov_b32 v9, v2
    s_mov_b32 s37, 4
L_safet_42:
    ds_read_b128 v[104:107], v9
    ds_read_b128 v[108:111], v9 offset:1024
    ds_read_b128 v[112:115], v9 offset:2048
    ds_read_b128 v[116:119], v9 offset:3072
    s_waitcnt lgkmcnt(0)
    v_mfma_f32_32x32x16_bf16 v[32:47], v[104:107], v[16:19], 0
    v_mfma_f32_32x32x16_bf16 v[32:47], v[108:111], v[20:23], v[32:47]
    s_nop 15
    v_max3_f32 v4, v32, v33, v34
    v_max3_f32 v4, v4, v35, v36
    v_max3_f32 v4, v4, v37, v38
    v_max3_f32 v4, v4, v39, v40
    v_max3_f32 v4, v4, v41, v42
    v_max3_f32 v4, v4, v43, v44
    v_max3_f32 v4, v4, v45, v46
    v_max_f32 v4, v4, v47
    v_mov_b32 v5, v4
    s_nop 1
    v_permlane32_swap_b32 v4, v5
    v_max_f32 v4, v4, v5
    v_max_f32 v4, v4, v8
    v_sub_f32 v5, v8, v4
    v_exp_f32 v5, v5
    v_mov_b32 v8, v4
    v_sub_f32 v32, v32, v4
    v_sub_f32 v33, v33, v4
    v_sub_f32 v34, v34, v4
    v_sub_f32 v35, v35, v4
    v_sub_f32 v36, v36, v4
    v_sub_f32 v37, v37, v4
    v_sub_f32 v38, v38, v4
    v_sub_f32 v39, v39, v4
    v_sub_f32 v40, v40, v4
    v_sub_f32 v41, v41, v4
    v_sub_f32 v42, v42, v4
    v_sub_f32 v43, v43, v4
    v_sub_f32 v44, v44, v4
    v_sub_f32 v45, v45, v4
    v_sub_f32 v46, v46, v4
    v_sub_f32 v47, v47, v4
    v_exp_f32 v32, v32
    v_exp_f32 v33, v33
    v_exp_f32 v34, v34
    v_exp_f32 v35, v35
    v_exp_f32 v36, v36
    v_exp_f32 v37, v37
    v_exp_f32 v38, v38
    v_exp_f32 v39, v39
    v_exp_f32 v40, v40
    v_exp_f32 v41, v41
    v_exp_f32 v42, v42
    v_exp_f32 v43, v43
    v_exp_f32 v44, v44
    v_exp_f32 v45, v45
    v_exp_f32 v46, v46
    v_exp_f32 v47, v47
    v_mul_f32 v64, v64, v5
    v_mul_f32 v65, v65, v5
    v_mul_f32 v66, v66, v5
    v_mul_f32 v67, v67, v5
    v_mul_f32 v68, v68, v5
    v_mul_f32 v69, v69, v5
    v_mul_f32 v70, v70, v5
    v_mul_f32 v71, v71, v5
    v_mul_f32 v72, v72, v5
    v_mul_f32 v73, v73, v5
    v_mul_f32 v74, v74, v5
    v_mul_f32 v75, v75, v5
    v_mul_f32 v76, v76, v5
    v_mul_f32 v77, v77, v5
    v_mul_f32 v78, v78, v5
    v_mul_f32 v79, v79, v5
    v_mul_f32 v24, v24, v5
    v_mul_f32 v25, v25, v5
    v_cvt_pk_bf16_f32 v96, v32, v33
    v_cvt_pk_bf16_f32 v97, v34, v35
    v_cvt_pk_bf16_f32 v98, v36, v37
    v_cvt_pk_bf16_f32 v99, v38, v39
    v_cvt_pk_bf16_f32 v100, v40, v41
    v_cvt_pk_bf16_f32 v101, v42, v43
    v_cvt_pk_bf16_f32 v102, v44, v45
    v_cvt_pk_bf16_f32 v103, v46, v47
    s_nop 1
    v_mfma_f32_32x32x16_bf16 v[64:79], v[112:115], v[96:99], v[64:79]
    v_mfma_f32_32x32x16_bf16 v[64:79], v[116:119], v[100:103], v[64:79]
    v_smfmac_f32_16x16x64_bf16 v[24:27], v[28:31], v[96:103], v15
    s_nop 15
    v_add_u32 v9, 4096, v9
    s_sub_u32 s37, s37, 1
    s_cmp_lg_u32 s37, 0
    s_cbranch_scc1 L_safet_42
    s_add_u32 s35, s35, 1
    s_cmp_lt_u32 s35, 16
    s_cbranch_scc1 L_safe_41
    v_add_f32 v4, v24, v25
    s_mov_b32 s59, 1
    s_barrier
    s_branch L_back
.section .rodata,"a"
.p2align 6
.amdhsa_kernel parallel_sum__mha_block__moe_arch_mod__prompt_kernel
  .amdhsa_next_free_vgpr 256
  .amdhsa_next_free_sgpr 96
  .amdhsa_accum_offset 128
  .amdhsa_group_segment_fixed_size 0
  .amdhsa_kernarg_size 88
  .amdhsa_user_sgpr_count 2
  .amdhsa_user_sgpr_kernarg_segment_ptr 1
  .amdhsa_system_sgpr_workgroup_id_x 1
.end_amdhsa_kernel
```
